```python
import torch

def _softmax(x, axis=-1):
    return torch.softmax(x, dim=axis)
def _gelu(x):
    return torch.nn.functional.gelu(x, approximate="tanh")
def _silu(x):
    return torch.nn.functional.silu(x)
def _sigmoid(x):
    return torch.sigmoid(x)
def _layernorm(x, axis=-1, eps=1e-5):
    m = x.mean(dim=axis, keepdim=True)
    v = x.var(dim=axis, keepdim=True, unbiased=False)
    return (x - m) / torch.sqrt(v + eps)
def _scatter_add(tgt, idx, src, axis=0):
    return tgt.clone().index_add_(axis, idx, src)
def _segment_sum(src, seg, n):
    out = torch.zeros((n,) + src.shape[1:], dtype=src.dtype)
    return out.index_add_(0, seg, src)
def _pad(x, pw):
    flat = tuple(v for pair in reversed(pw) for v in pair)
    return torch.nn.functional.pad(x, flat)

kernel_name = 'recurrent_scan__mha_block__glu_gated_swiglu__prompt'

def setup_inputs():

    _w = (lambda a: (lambda t: t.to(torch.bfloat16) if t.is_floating_point() else t)(torch.as_tensor(a)))
    def _A_setup():
        B, S, D, H = 1, 2048, 512, 32
        return {
            "x": _w((lambda *s: torch.randn(*s, dtype=torch.bfloat16) * 0.05)(B, S, D)),
            "wqkv": _w((lambda *s: torch.randn(*s, dtype=torch.bfloat16) * 0.2)(D, 3 * D)),
            "wo": _w((lambda *s: torch.randn(*s, dtype=torch.bfloat16) * 0.2)(D, D)),
        }
    _A_in = _A_setup()

    def _B_setup():
        B, S, D, F = 1, 2048, 512, 1376
        return {
            "x": _w((lambda *s: torch.randn(*s, dtype=torch.bfloat16) * 0.05)(B, S, D)),
            "w1": _w((lambda *s: torch.randn(*s, dtype=torch.bfloat16) * 0.1)(D, F) * (2.0 / D) ** 0.5),
            "w3": _w((lambda *s: torch.randn(*s, dtype=torch.bfloat16) * 0.1)(D, F) * (2.0 / D) ** 0.5),
            "w2": _w((lambda *s: torch.randn(*s, dtype=torch.bfloat16) * 0.1)(F, D) * (2.0 / F) ** 0.5),
        }
    _B_in = _B_setup()

    return {
        "A_x": _A_in["x"],
        "A_wqkv": _A_in["wqkv"],
        "A_wo": _A_in["wo"],
        "B_x": _B_in["x"],
        "B_w1": _B_in["w1"],
        "B_w3": _B_in["w3"],
        "B_w2": _B_in["w2"],
    }

def reference(A_x, A_wqkv, A_wo, B_x, B_w1, B_w3, B_w2):
    def _A_ref(x, wqkv, wo):
        B, S, D = x.shape
        H = 32
        Dh = D // H
        qkv = (lambda x, *d: x.permute(*d))((x @ wqkv).reshape(B, S, 3, H, Dh), 2, 0, 3, 1, 4)
        q, k, v = qkv[0], qkv[1], qkv[2]
        scores = torch.einsum("bhqd,bhkd->bhqk", q, k) * (Dh ** -0.5)
        p = _softmax(scores, axis=-1)
        o = torch.einsum("bhqk,bhkd->bhqd", p, v)
        return (lambda x, *d: x.permute(*d))(o, 0, 2, 1, 3).reshape(B, S, D) @ wo

    def _B_ref(x, w1, w3, w2):
        gate = torch.einsum("bsd,df->bsf", x, w1)
        up = torch.einsum("bsd,df->bsf", x, w3)
        h = _silu(gate) * up
        out = torch.einsum("bsf,fd->bsd", h, w2)
        return out

    x = A_x
    xn = _layernorm(x, axis=-1)
    s = _A_ref(xn, A_wqkv, A_wo)
    g = _silu(_B_ref(xn, B_w1, B_w3, B_w2))
    return x + s * g
```

```asm
; @launch kernel=k1_kernel grid=(256,1,1) block=(768,1,1) lds=155648
; @launch kernel=k2_kernel grid=(256,1,1) block=(768,1,1) lds=131136
.amdgcn_target "amdgcn-amd-amdhsa--gfx950"
.text
.globl k1_kernel
.p2align 8
.type k1_kernel,@function
k1_kernel:
  s_cmp_ge_u32 s2, 256
  s_cbranch_scc1 k1_kernel_end
  s_load_dwordx4 s[4:7], s[0:1], 0
  s_load_dwordx4 s[12:15], s[0:1], 32
  s_load_dwordx2 s[16:17], s[0:1], 48
  s_load_dwordx2 s[22:23], s[0:1], 16
  s_load_dwordx2 s[20:21], s[0:1], 72
  v_and_b32 v1, 63, v0
  v_lshrrev_b32 v2, 6, v0
  s_and_b32 s40, s2, 7
  s_lshr_b32 s41, s2, 3
  v_readfirstlane_b32 s42, v2
  s_lshr_b32 s43, s40, 1
  s_lshl_b32 s43, s43, 3
  s_lshr_b32 s73, s41, 2
  s_add_u32 s43, s43, s73
  s_and_b32 s44, s40, 1
  s_lshl_b32 s44, s44, 2
  s_and_b32 s45, s41, 3
  s_add_u32 s44, s44, s45
  v_lshrrev_b32 v3, 3, v1
  v_and_b32 v5, 7, v1
  v_lshlrev_b32 v4, 10, v3
  v_lshl_add_u32 v4, v5, 4, v4
  s_lshl_b32 s45, s43, 16
  s_lshl_b32 s46, s42, 13
  s_add_u32 s45, s45, s46
  v_mov_b32 v7, v0
  s_cmp_ge_u32 s42, 8
  s_cbranch_scc1 k1_kernel_idle
  s_waitcnt lgkmcnt(0)
  s_mov_b32 s24, s4
  s_mov_b32 s25, s5
  s_mov_b32 s26, 0x200000
  s_mov_b32 s27, 0x20000
  buffer_load_dwordx4 v[64:67], v4, s[24:27], s45 offen offset:0
  buffer_load_dwordx4 v[68:71], v4, s[24:27], s45 offen offset:128
  buffer_load_dwordx4 v[72:75], v4, s[24:27], s45 offen offset:256
  buffer_load_dwordx4 v[76:79], v4, s[24:27], s45 offen offset:384
  buffer_load_dwordx4 v[80:83], v4, s[24:27], s45 offen offset:512
  buffer_load_dwordx4 v[84:87], v4, s[24:27], s45 offen offset:640
  buffer_load_dwordx4 v[88:91], v4, s[24:27], s45 offen offset:768
  buffer_load_dwordx4 v[92:95], v4, s[24:27], s45 offen offset:896
  s_mov_b32 s36, s20
  s_mov_b32 s37, s21
  s_mov_b32 s38, 0x1a00000
  s_mov_b32 s39, 0x20000
  s_lshr_b32 s46, s42, 2
  s_mul_i32 s46, s46, 34816
  s_and_b32 s47, s42, 3
  s_lshl_b32 s47, s47, 7
  s_add_u32 s46, s46, s47
  v_mul_u32_u24 v6, 544, v5
  v_lshl_add_u32 v6, v3, 4, v6
  v_add_u32 v6, s46, v6
  v_mov_b32 v36, 0xffff0000
  s_cmp_ge_u32 s42, 4
  s_cbranch_scc1 k1_kernel_help
  s_lshr_b32 s46, s42, 1
  s_mul_i32 s47, s46, 34816
  s_and_b32 s48, s42, 1
  v_and_b32 v11, 31, v1
  v_lshrrev_b32 v12, 5, v1
  v_mul_u32_u24 v24, 544, v12
  v_lshl_add_u32 v24, v11, 4, v24
  v_add_u32 v24, s47, v24
  v_bfe_u32 v13, v1, 2, 2
  v_lshl_add_u32 v14, v12, 3, v13
  v_mul_u32_u24 v14, 0x180, v14
  v_lshrrev_b32 v13, 1, v13
  v_xor_b32 v13, s48, v13
  v_lshl_add_u32 v14, v13, 6, v14
  v_bfe_u32 v13, v1, 4, 1
  v_lshl_add_u32 v14, v13, 5, v14
  v_and_b32 v13, 3, v1
  v_lshl_add_u32 v28, v13, 3, v14
  v_lshlrev_b32 v2, 4, v1
  v_mov_b32 v48, 0
  v_mov_b32 v49, 0
  v_mov_b32 v50, 0
  v_mov_b32 v51, 0
  s_waitcnt vmcnt(7)
  v_lshlrev_b32 v96, 16, v64
  v_and_b32 v97, v36, v64
  v_add_f32 v48, v48, v96
  v_add_f32 v49, v49, v97
  v_fmac_f32 v50, v96, v96
  v_fmac_f32 v51, v97, v97
  v_lshlrev_b32 v98, 16, v65
  v_and_b32 v99, v36, v65
  v_add_f32 v48, v48, v98
  v_add_f32 v49, v49, v99
  v_fmac_f32 v50, v98, v98
  v_fmac_f32 v51, v99, v99
  v_lshlrev_b32 v100, 16, v66
  v_and_b32 v101, v36, v66
  v_add_f32 v48, v48, v100
  v_add_f32 v49, v49, v101
  v_fmac_f32 v50, v100, v100
  v_fmac_f32 v51, v101, v101
  v_lshlrev_b32 v102, 16, v67
  v_and_b32 v103, v36, v67
  v_add_f32 v48, v48, v102
  v_add_f32 v49, v49, v103
  v_fmac_f32 v50, v102, v102
  v_fmac_f32 v51, v103, v103
  s_waitcnt vmcnt(6)
  v_lshlrev_b32 v104, 16, v68
  v_and_b32 v105, v36, v68
  v_add_f32 v48, v48, v104
  v_add_f32 v49, v49, v105
  v_fmac_f32 v50, v104, v104
  v_fmac_f32 v51, v105, v105
  v_lshlrev_b32 v106, 16, v69
  v_and_b32 v107, v36, v69
  v_add_f32 v48, v48, v106
  v_add_f32 v49, v49, v107
  v_fmac_f32 v50, v106, v106
  v_fmac_f32 v51, v107, v107
  v_lshlrev_b32 v108, 16, v70
  v_and_b32 v109, v36, v70
  v_add_f32 v48, v48, v108
  v_add_f32 v49, v49, v109
  v_fmac_f32 v50, v108, v108
  v_fmac_f32 v51, v109, v109
  v_lshlrev_b32 v110, 16, v71
  v_and_b32 v111, v36, v71
  v_add_f32 v48, v48, v110
  v_add_f32 v49, v49, v111
  v_fmac_f32 v50, v110, v110
  v_fmac_f32 v51, v111, v111
  s_waitcnt vmcnt(5)
  v_lshlrev_b32 v112, 16, v72
  v_and_b32 v113, v36, v72
  v_add_f32 v48, v48, v112
  v_add_f32 v49, v49, v113
  v_fmac_f32 v50, v112, v112
  v_fmac_f32 v51, v113, v113
  v_lshlrev_b32 v114, 16, v73
  v_and_b32 v115, v36, v73
  v_add_f32 v48, v48, v114
  v_add_f32 v49, v49, v115
  v_fmac_f32 v50, v114, v114
  v_fmac_f32 v51, v115, v115
  v_lshlrev_b32 v116, 16, v74
  v_and_b32 v117, v36, v74
  v_add_f32 v48, v48, v116
  v_add_f32 v49, v49, v117
  v_fmac_f32 v50, v116, v116
  v_fmac_f32 v51, v117, v117
  v_lshlrev_b32 v118, 16, v75
  v_and_b32 v119, v36, v75
  v_add_f32 v48, v48, v118
  v_add_f32 v49, v49, v119
  v_fmac_f32 v50, v118, v118
  v_fmac_f32 v51, v119, v119
  s_waitcnt vmcnt(4)
  v_lshlrev_b32 v120, 16, v76
  v_and_b32 v121, v36, v76
  v_add_f32 v48, v48, v120
  v_add_f32 v49, v49, v121
  v_fmac_f32 v50, v120, v120
  v_fmac_f32 v51, v121, v121
  v_lshlrev_b32 v122, 16, v77
  v_and_b32 v123, v36, v77
  v_add_f32 v48, v48, v122
  v_add_f32 v49, v49, v123
  v_fmac_f32 v50, v122, v122
  v_fmac_f32 v51, v123, v123
  v_lshlrev_b32 v124, 16, v78
  v_and_b32 v125, v36, v78
  v_add_f32 v48, v48, v124
  v_add_f32 v49, v49, v125
  v_fmac_f32 v50, v124, v124
  v_fmac_f32 v51, v125, v125
  v_lshlrev_b32 v126, 16, v79
  v_and_b32 v127, v36, v79
  v_add_f32 v48, v48, v126
  v_add_f32 v49, v49, v127
  v_fmac_f32 v50, v126, v126
  v_fmac_f32 v51, v127, v127
  s_waitcnt vmcnt(3)
  v_lshlrev_b32 v128, 16, v80
  v_and_b32 v129, v36, v80
  v_add_f32 v48, v48, v128
  v_add_f32 v49, v49, v129
  v_fmac_f32 v50, v128, v128
  v_fmac_f32 v51, v129, v129
  v_lshlrev_b32 v130, 16, v81
  v_and_b32 v131, v36, v81
  v_add_f32 v48, v48, v130
  v_add_f32 v49, v49, v131
  v_fmac_f32 v50, v130, v130
  v_fmac_f32 v51, v131, v131
  v_lshlrev_b32 v132, 16, v82
  v_and_b32 v133, v36, v82
  v_add_f32 v48, v48, v132
  v_add_f32 v49, v49, v133
  v_fmac_f32 v50, v132, v132
  v_fmac_f32 v51, v133, v133
  v_lshlrev_b32 v134, 16, v83
  v_and_b32 v135, v36, v83
  v_add_f32 v48, v48, v134
  v_add_f32 v49, v49, v135
  v_fmac_f32 v50, v134, v134
  v_fmac_f32 v51, v135, v135
  s_waitcnt vmcnt(2)
  v_lshlrev_b32 v136, 16, v84
  v_and_b32 v137, v36, v84
  v_add_f32 v48, v48, v136
  v_add_f32 v49, v49, v137
  v_fmac_f32 v50, v136, v136
  v_fmac_f32 v51, v137, v137
  v_lshlrev_b32 v138, 16, v85
  v_and_b32 v139, v36, v85
  v_add_f32 v48, v48, v138
  v_add_f32 v49, v49, v139
  v_fmac_f32 v50, v138, v138
  v_fmac_f32 v51, v139, v139
  v_lshlrev_b32 v140, 16, v86
  v_and_b32 v141, v36, v86
  v_add_f32 v48, v48, v140
  v_add_f32 v49, v49, v141
  v_fmac_f32 v50, v140, v140
  v_fmac_f32 v51, v141, v141
  v_lshlrev_b32 v142, 16, v87
  v_and_b32 v143, v36, v87
  v_add_f32 v48, v48, v142
  v_add_f32 v49, v49, v143
  v_fmac_f32 v50, v142, v142
  v_fmac_f32 v51, v143, v143
  s_waitcnt vmcnt(1)
  v_lshlrev_b32 v144, 16, v88
  v_and_b32 v145, v36, v88
  v_add_f32 v48, v48, v144
  v_add_f32 v49, v49, v145
  v_fmac_f32 v50, v144, v144
  v_fmac_f32 v51, v145, v145
  v_lshlrev_b32 v146, 16, v89
  v_and_b32 v147, v36, v89
  v_add_f32 v48, v48, v146
  v_add_f32 v49, v49, v147
  v_fmac_f32 v50, v146, v146
  v_fmac_f32 v51, v147, v147
  v_lshlrev_b32 v148, 16, v90
  v_and_b32 v149, v36, v90
  v_add_f32 v48, v48, v148
  v_add_f32 v49, v49, v149
  v_fmac_f32 v50, v148, v148
  v_fmac_f32 v51, v149, v149
  v_lshlrev_b32 v150, 16, v91
  v_and_b32 v151, v36, v91
  v_add_f32 v48, v48, v150
  v_add_f32 v49, v49, v151
  v_fmac_f32 v50, v150, v150
  v_fmac_f32 v51, v151, v151
  s_waitcnt vmcnt(0)
  v_lshlrev_b32 v152, 16, v92
  v_and_b32 v153, v36, v92
  v_add_f32 v48, v48, v152
  v_add_f32 v49, v49, v153
  v_fmac_f32 v50, v152, v152
  v_fmac_f32 v51, v153, v153
  v_lshlrev_b32 v154, 16, v93
  v_and_b32 v155, v36, v93
  v_add_f32 v48, v48, v154
  v_add_f32 v49, v49, v155
  v_fmac_f32 v50, v154, v154
  v_fmac_f32 v51, v155, v155
  v_lshlrev_b32 v156, 16, v94
  v_and_b32 v157, v36, v94
  v_add_f32 v48, v48, v156
  v_add_f32 v49, v49, v157
  v_fmac_f32 v50, v156, v156
  v_fmac_f32 v51, v157, v157
  v_lshlrev_b32 v158, 16, v95
  v_and_b32 v159, v36, v95
  v_add_f32 v48, v48, v158
  v_add_f32 v49, v49, v159
  v_fmac_f32 v50, v158, v158
  v_fmac_f32 v51, v159, v159
  v_add_f32 v48, v48, v49
  v_add_f32 v50, v50, v51
  s_nop 1
  v_add_f32_dpp v48, v48, v48 quad_perm:[1,0,3,2] row_mask:0xf bank_mask:0xf
  v_add_f32_dpp v50, v50, v50 quad_perm:[1,0,3,2] row_mask:0xf bank_mask:0xf
  s_nop 1
  v_add_f32_dpp v48, v48, v48 quad_perm:[2,3,0,1] row_mask:0xf bank_mask:0xf
  v_add_f32_dpp v50, v50, v50 quad_perm:[2,3,0,1] row_mask:0xf bank_mask:0xf
  s_nop 1
  v_add_f32_dpp v48, v48, v48 row_half_mirror row_mask:0xf bank_mask:0xf
  v_add_f32_dpp v50, v50, v50 row_half_mirror row_mask:0xf bank_mask:0xf
  s_nop 1
  v_mul_f32 v48, 0x3b000000, v48
  v_mul_f32 v50, 0x3b000000, v50
  v_fma_f32 v50, -v48, v48, v50
  v_max_f32 v50, 0, v50
  v_add_f32 v50, 0x3727c5ac, v50
  v_rsq_f32 v49, v50
  s_nop 0
  v_mul_f32 v50, v48, v49
  v_sub_f32 v50, 0, v50
  v_fma_f32 v96, v96, v49, v50
  v_fma_f32 v97, v97, v49, v50
  v_fma_f32 v98, v98, v49, v50
  v_fma_f32 v99, v99, v49, v50
  v_fma_f32 v100, v100, v49, v50
  v_fma_f32 v101, v101, v49, v50
  v_fma_f32 v102, v102, v49, v50
  v_fma_f32 v103, v103, v49, v50
  v_cvt_pk_bf16_f32 v64, v96, v97
  v_cvt_pk_bf16_f32 v65, v98, v99
  v_cvt_pk_bf16_f32 v66, v100, v101
  v_cvt_pk_bf16_f32 v67, v102, v103
  ds_write_b128 v6, v[64:67] offset:0
  v_fma_f32 v104, v104, v49, v50
  v_fma_f32 v105, v105, v49, v50
  v_fma_f32 v106, v106, v49, v50
  v_fma_f32 v107, v107, v49, v50
  v_fma_f32 v108, v108, v49, v50
  v_fma_f32 v109, v109, v49, v50
  v_fma_f32 v110, v110, v49, v50
  v_fma_f32 v111, v111, v49, v50
  v_cvt_pk_bf16_f32 v68, v104, v105
  v_cvt_pk_bf16_f32 v69, v106, v107
  v_cvt_pk_bf16_f32 v70, v108, v109
  v_cvt_pk_bf16_f32 v71, v110, v111
  ds_write_b128 v6, v[68:71] offset:4352
  v_fma_f32 v112, v112, v49, v50
  v_fma_f32 v113, v113, v49, v50
  v_fma_f32 v114, v114, v49, v50
  v_fma_f32 v115, v115, v49, v50
  v_fma_f32 v116, v116, v49, v50
  v_fma_f32 v117, v117, v49, v50
  v_fma_f32 v118, v118, v49, v50
  v_fma_f32 v119, v119, v49, v50
  v_cvt_pk_bf16_f32 v72, v112, v113
  v_cvt_pk_bf16_f32 v73, v114, v115
  v_cvt_pk_bf16_f32 v74, v116, v117
  v_cvt_pk_bf16_f32 v75, v118, v119
  ds_write_b128 v6, v[72:75] offset:8704
  v_fma_f32 v120, v120, v49, v50
  v_fma_f32 v121, v121, v49, v50
  v_fma_f32 v122, v122, v49, v50
  v_fma_f32 v123, v123, v49, v50
  v_fma_f32 v124, v124, v49, v50
  v_fma_f32 v125, v125, v49, v50
  v_fma_f32 v126, v126, v49, v50
  v_fma_f32 v127, v127, v49, v50
  v_cvt_pk_bf16_f32 v76, v120, v121
  v_cvt_pk_bf16_f32 v77, v122, v123
  v_cvt_pk_bf16_f32 v78, v124, v125
  v_cvt_pk_bf16_f32 v79, v126, v127
  ds_write_b128 v6, v[76:79] offset:13056
  v_fma_f32 v128, v128, v49, v50
  v_fma_f32 v129, v129, v49, v50
  v_fma_f32 v130, v130, v49, v50
  v_fma_f32 v131, v131, v49, v50
  v_fma_f32 v132, v132, v49, v50
  v_fma_f32 v133, v133, v49, v50
  v_fma_f32 v134, v134, v49, v50
  v_fma_f32 v135, v135, v49, v50
  v_cvt_pk_bf16_f32 v80, v128, v129
  v_cvt_pk_bf16_f32 v81, v130, v131
  v_cvt_pk_bf16_f32 v82, v132, v133
  v_cvt_pk_bf16_f32 v83, v134, v135
  ds_write_b128 v6, v[80:83] offset:17408
  v_fma_f32 v136, v136, v49, v50
  v_fma_f32 v137, v137, v49, v50
  v_fma_f32 v138, v138, v49, v50
  v_fma_f32 v139, v139, v49, v50
  v_fma_f32 v140, v140, v49, v50
  v_fma_f32 v141, v141, v49, v50
  v_fma_f32 v142, v142, v49, v50
  v_fma_f32 v143, v143, v49, v50
  v_cvt_pk_bf16_f32 v84, v136, v137
  v_cvt_pk_bf16_f32 v85, v138, v139
  v_cvt_pk_bf16_f32 v86, v140, v141
  v_cvt_pk_bf16_f32 v87, v142, v143
  ds_write_b128 v6, v[84:87] offset:21760
  v_fma_f32 v144, v144, v49, v50
  v_fma_f32 v145, v145, v49, v50
  v_fma_f32 v146, v146, v49, v50
  v_fma_f32 v147, v147, v49, v50
  v_fma_f32 v148, v148, v49, v50
  v_fma_f32 v149, v149, v49, v50
  v_fma_f32 v150, v150, v49, v50
  v_fma_f32 v151, v151, v49, v50
  v_cvt_pk_bf16_f32 v88, v144, v145
  v_cvt_pk_bf16_f32 v89, v146, v147
  v_cvt_pk_bf16_f32 v90, v148, v149
  v_cvt_pk_bf16_f32 v91, v150, v151
  ds_write_b128 v6, v[88:91] offset:26112
  v_fma_f32 v152, v152, v49, v50
  v_fma_f32 v153, v153, v49, v50
  v_fma_f32 v154, v154, v49, v50
  v_fma_f32 v155, v155, v49, v50
  v_fma_f32 v156, v156, v49, v50
  v_fma_f32 v157, v157, v49, v50
  v_fma_f32 v158, v158, v49, v50
  v_fma_f32 v159, v159, v49, v50
  v_cvt_pk_bf16_f32 v92, v152, v153
  v_cvt_pk_bf16_f32 v93, v154, v155
  v_cvt_pk_bf16_f32 v94, v156, v157
  v_cvt_pk_bf16_f32 v95, v158, v159
  ds_write_b128 v6, v[92:95] offset:30464
  v_mov_b32 v96, 0
  v_mov_b32 v97, 0
  v_mov_b32 v98, 0
  v_mov_b32 v99, 0
  v_mov_b32 v100, 0
  v_mov_b32 v101, 0
  v_mov_b32 v102, 0
  v_mov_b32 v103, 0
  v_mov_b32 v104, 0
  v_mov_b32 v105, 0
  v_mov_b32 v106, 0
  v_mov_b32 v107, 0
  v_mov_b32 v108, 0
  v_mov_b32 v109, 0
  v_mov_b32 v110, 0
  v_mov_b32 v111, 0
  v_mov_b32 v112, 0
  v_mov_b32 v113, 0
  v_mov_b32 v114, 0
  v_mov_b32 v115, 0
  v_mov_b32 v116, 0
  v_mov_b32 v117, 0
  v_mov_b32 v118, 0
  v_mov_b32 v119, 0
  v_mov_b32 v120, 0
  v_mov_b32 v121, 0
  v_mov_b32 v122, 0
  v_mov_b32 v123, 0
  v_mov_b32 v124, 0
  v_mov_b32 v125, 0
  v_mov_b32 v126, 0
  v_mov_b32 v127, 0
  v_mov_b32 v128, 0
  v_mov_b32 v129, 0
  v_mov_b32 v130, 0
  v_mov_b32 v131, 0
  v_mov_b32 v132, 0
  v_mov_b32 v133, 0
  v_mov_b32 v134, 0
  v_mov_b32 v135, 0
  v_mov_b32 v136, 0
  v_mov_b32 v137, 0
  v_mov_b32 v138, 0
  v_mov_b32 v139, 0
  v_mov_b32 v140, 0
  v_mov_b32 v141, 0
  v_mov_b32 v142, 0
  v_mov_b32 v143, 0
  s_add_u32 s74, s73, 0
  s_and_b32 s74, s74, 7
  s_mul_i32 s74, s74, 4352
  v_add_u32 v34, 69632, v28
  v_add_u32 v30, s74, v24
  s_waitcnt lgkmcnt(0)
  s_barrier
  ds_read_b128 v[40:43], v30 offset:0
  ds_read_b64_tr_b16 v[8:9], v34 offset:0
  ds_read_b64_tr_b16 v[10:11], v34 offset:1536
  ds_read_b64_tr_b16 v[12:13], v34 offset:128
  ds_read_b64_tr_b16 v[14:15], v34 offset:1664
  ds_read_b64_tr_b16 v[16:17], v34 offset:256
  ds_read_b64_tr_b16 v[18:19], v34 offset:1792
  ds_read_b128 v[44:47], v30 offset:1088
  ds_read_b64_tr_b16 v[52:53], v34 offset:6144
  ds_read_b64_tr_b16 v[54:55], v34 offset:7680
  ds_read_b64_tr_b16 v[56:57], v34 offset:6272
  ds_read_b64_tr_b16 v[58:59], v34 offset:7808
  ds_read_b64_tr_b16 v[60:61], v34 offset:6400
  ds_read_b64_tr_b16 v[62:63], v34 offset:7936
  s_waitcnt lgkmcnt(7)
  v_mfma_f32_32x32x16_bf16 v[96:111], v[8:11], v[40:43], v[96:111]
  v_mfma_f32_32x32x16_bf16 v[112:127], v[12:15], v[40:43], v[112:127]
  v_mfma_f32_32x32x16_bf16 v[128:143], v[40:43], v[16:19], v[128:143]
  ds_read_b128 v[40:43], v30 offset:2176
  ds_read_b64_tr_b16 v[8:9], v34 offset:12288
  ds_read_b64_tr_b16 v[10:11], v34 offset:13824
  ds_read_b64_tr_b16 v[12:13], v34 offset:12416
  ds_read_b64_tr_b16 v[14:15], v34 offset:13952
  ds_read_b64_tr_b16 v[16:17], v34 offset:12544
  ds_read_b64_tr_b16 v[18:19], v34 offset:14080
  s_waitcnt lgkmcnt(7)
  v_mfma_f32_32x32x16_bf16 v[96:111], v[52:55], v[44:47], v[96:111]
  v_mfma_f32_32x32x16_bf16 v[112:127], v[56:59], v[44:47], v[112:127]
  v_mfma_f32_32x32x16_bf16 v[128:143], v[44:47], v[60:63], v[128:143]
  ds_read_b128 v[44:47], v30 offset:3264
  ds_read_b64_tr_b16 v[52:53], v34 offset:18432
  ds_read_b64_tr_b16 v[54:55], v34 offset:19968
  ds_read_b64_tr_b16 v[56:57], v34 offset:18560
  ds_read_b64_tr_b16 v[58:59], v34 offset:20096
  ds_read_b64_tr_b16 v[60:61], v34 offset:18688
  ds_read_b64_tr_b16 v[62:63], v34 offset:20224
  s_waitcnt lgkmcnt(7)
  v_mfma_f32_32x32x16_bf16 v[96:111], v[8:11], v[40:43], v[96:111]
  v_mfma_f32_32x32x16_bf16 v[112:127], v[12:15], v[40:43], v[112:127]
  v_mfma_f32_32x32x16_bf16 v[128:143], v[40:43], v[16:19], v[128:143]
  s_waitcnt lgkmcnt(0)
  s_add_u32 s74, s73, 1
  s_and_b32 s74, s74, 7
  s_mul_i32 s74, s74, 4352
  v_add_u32 v34, 94208, v28
  v_add_u32 v30, s74, v24
  s_barrier
  ds_read_b128 v[40:43], v30 offset:0
  ds_read_b64_tr_b16 v[8:9], v34 offset:0
  ds_read_b64_tr_b16 v[10:11], v34 offset:1536
  ds_read_b64_tr_b16 v[12:13], v34 offset:128
  ds_read_b64_tr_b16 v[14:15], v34 offset:1664
  ds_read_b64_tr_b16 v[16:17], v34 offset:256
  ds_read_b64_tr_b16 v[18:19], v34 offset:1792
  v_mfma_f32_32x32x16_bf16 v[96:111], v[52:55], v[44:47], v[96:111]
  v_mfma_f32_32x32x16_bf16 v[112:127], v[56:59], v[44:47], v[112:127]
  v_mfma_f32_32x32x16_bf16 v[128:143], v[44:47], v[60:63], v[128:143]
  ds_read_b128 v[44:47], v30 offset:1088
  ds_read_b64_tr_b16 v[52:53], v34 offset:6144
  ds_read_b64_tr_b16 v[54:55], v34 offset:7680
  ds_read_b64_tr_b16 v[56:57], v34 offset:6272
  ds_read_b64_tr_b16 v[58:59], v34 offset:7808
  ds_read_b64_tr_b16 v[60:61], v34 offset:6400
  ds_read_b64_tr_b16 v[62:63], v34 offset:7936
  s_waitcnt lgkmcnt(7)
  v_mfma_f32_32x32x16_bf16 v[96:111], v[8:11], v[40:43], v[96:111]
  v_mfma_f32_32x32x16_bf16 v[112:127], v[12:15], v[40:43], v[112:127]
  v_mfma_f32_32x32x16_bf16 v[128:143], v[40:43], v[16:19], v[128:143]
  ds_read_b128 v[40:43], v30 offset:2176
  ds_read_b64_tr_b16 v[8:9], v34 offset:12288
  ds_read_b64_tr_b16 v[10:11], v34 offset:13824
  ds_read_b64_tr_b16 v[12:13], v34 offset:12416
  ds_read_b64_tr_b16 v[14:15], v34 offset:13952
  ds_read_b64_tr_b16 v[16:17], v34 offset:12544
  ds_read_b64_tr_b16 v[18:19], v34 offset:14080
  s_waitcnt lgkmcnt(7)
  v_mfma_f32_32x32x16_bf16 v[96:111], v[52:55], v[44:47], v[96:111]
  v_mfma_f32_32x32x16_bf16 v[112:127], v[56:59], v[44:47], v[112:127]
  v_mfma_f32_32x32x16_bf16 v[128:143], v[44:47], v[60:63], v[128:143]
  ds_read_b128 v[44:47], v30 offset:3264
  ds_read_b64_tr_b16 v[52:53], v34 offset:18432
  ds_read_b64_tr_b16 v[54:55], v34 offset:19968
  ds_read_b64_tr_b16 v[56:57], v34 offset:18560
  ds_read_b64_tr_b16 v[58:59], v34 offset:20096
  ds_read_b64_tr_b16 v[60:61], v34 offset:18688
  ds_read_b64_tr_b16 v[62:63], v34 offset:20224
  s_waitcnt lgkmcnt(7)
  v_mfma_f32_32x32x16_bf16 v[96:111], v[8:11], v[40:43], v[96:111]
  v_mfma_f32_32x32x16_bf16 v[112:127], v[12:15], v[40:43], v[112:127]
  v_mfma_f32_32x32x16_bf16 v[128:143], v[40:43], v[16:19], v[128:143]
  s_waitcnt lgkmcnt(0)
  s_add_u32 s74, s73, 2
  s_and_b32 s74, s74, 7
  s_mul_i32 s74, s74, 4352
  v_add_u32 v34, 118784, v28
  v_add_u32 v30, s74, v24
  s_barrier
  ds_read_b128 v[40:43], v30 offset:0
  ds_read_b64_tr_b16 v[8:9], v34 offset:0
  ds_read_b64_tr_b16 v[10:11], v34 offset:1536
  ds_read_b64_tr_b16 v[12:13], v34 offset:128
  ds_read_b64_tr_b16 v[14:15], v34 offset:1664
  ds_read_b64_tr_b16 v[16:17], v34 offset:256
  ds_read_b64_tr_b16 v[18:19], v34 offset:1792
  v_mfma_f32_32x32x16_bf16 v[96:111], v[52:55], v[44:47], v[96:111]
  v_mfma_f32_32x32x16_bf16 v[112:127], v[56:59], v[44:47], v[112:127]
  v_mfma_f32_32x32x16_bf16 v[128:143], v[44:47], v[60:63], v[128:143]
  ds_read_b128 v[44:47], v30 offset:1088
  ds_read_b64_tr_b16 v[52:53], v34 offset:6144
  ds_read_b64_tr_b16 v[54:55], v34 offset:7680
  ds_read_b64_tr_b16 v[56:57], v34 offset:6272
  ds_read_b64_tr_b16 v[58:59], v34 offset:7808
  ds_read_b64_tr_b16 v[60:61], v34 offset:6400
  ds_read_b64_tr_b16 v[62:63], v34 offset:7936
  s_waitcnt lgkmcnt(7)
  v_mfma_f32_32x32x16_bf16 v[96:111], v[8:11], v[40:43], v[96:111]
  v_mfma_f32_32x32x16_bf16 v[112:127], v[12:15], v[40:43], v[112:127]
  v_mfma_f32_32x32x16_bf16 v[128:143], v[40:43], v[16:19], v[128:143]
  ds_read_b128 v[40:43], v30 offset:2176
  ds_read_b64_tr_b16 v[8:9], v34 offset:12288
  ds_read_b64_tr_b16 v[10:11], v34 offset:13824
  ds_read_b64_tr_b16 v[12:13], v34 offset:12416
  ds_read_b64_tr_b16 v[14:15], v34 offset:13952
  ds_read_b64_tr_b16 v[16:17], v34 offset:12544
  ds_read_b64_tr_b16 v[18:19], v34 offset:14080
  s_waitcnt lgkmcnt(7)
  v_mfma_f32_32x32x16_bf16 v[96:111], v[52:55], v[44:47], v[96:111]
  v_mfma_f32_32x32x16_bf16 v[112:127], v[56:59], v[44:47], v[112:127]
  v_mfma_f32_32x32x16_bf16 v[128:143], v[44:47], v[60:63], v[128:143]
  ds_read_b128 v[44:47], v30 offset:3264
  ds_read_b64_tr_b16 v[52:53], v34 offset:18432
  ds_read_b64_tr_b16 v[54:55], v34 offset:19968
  ds_read_b64_tr_b16 v[56:57], v34 offset:18560
  ds_read_b64_tr_b16 v[58:59], v34 offset:20096
  ds_read_b64_tr_b16 v[60:61], v34 offset:18688
  ds_read_b64_tr_b16 v[62:63], v34 offset:20224
  s_waitcnt lgkmcnt(7)
  v_mfma_f32_32x32x16_bf16 v[96:111], v[8:11], v[40:43], v[96:111]
  v_mfma_f32_32x32x16_bf16 v[112:127], v[12:15], v[40:43], v[112:127]
  v_mfma_f32_32x32x16_bf16 v[128:143], v[40:43], v[16:19], v[128:143]
  s_waitcnt lgkmcnt(0)
  s_add_u32 s74, s73, 3
  s_and_b32 s74, s74, 7
  s_mul_i32 s74, s74, 4352
  v_add_u32 v34, 69632, v28
  v_add_u32 v30, s74, v24
  s_barrier
  ds_read_b128 v[40:43], v30 offset:0
  ds_read_b64_tr_b16 v[8:9], v34 offset:0
  ds_read_b64_tr_b16 v[10:11], v34 offset:1536
  ds_read_b64_tr_b16 v[12:13], v34 offset:128
  ds_read_b64_tr_b16 v[14:15], v34 offset:1664
  ds_read_b64_tr_b16 v[16:17], v34 offset:256
  ds_read_b64_tr_b16 v[18:19], v34 offset:1792
  v_mfma_f32_32x32x16_bf16 v[96:111], v[52:55], v[44:47], v[96:111]
  v_mfma_f32_32x32x16_bf16 v[112:127], v[56:59], v[44:47], v[112:127]
  v_mfma_f32_32x32x16_bf16 v[128:143], v[44:47], v[60:63], v[128:143]
  ds_read_b128 v[44:47], v30 offset:1088
  ds_read_b64_tr_b16 v[52:53], v34 offset:6144
  ds_read_b64_tr_b16 v[54:55], v34 offset:7680
  ds_read_b64_tr_b16 v[56:57], v34 offset:6272
  ds_read_b64_tr_b16 v[58:59], v34 offset:7808
  ds_read_b64_tr_b16 v[60:61], v34 offset:6400
  ds_read_b64_tr_b16 v[62:63], v34 offset:7936
  s_waitcnt lgkmcnt(7)
  v_mfma_f32_32x32x16_bf16 v[96:111], v[8:11], v[40:43], v[96:111]
  v_mfma_f32_32x32x16_bf16 v[112:127], v[12:15], v[40:43], v[112:127]
  v_mfma_f32_32x32x16_bf16 v[128:143], v[40:43], v[16:19], v[128:143]
  ds_read_b128 v[40:43], v30 offset:2176
  ds_read_b64_tr_b16 v[8:9], v34 offset:12288
  ds_read_b64_tr_b16 v[10:11], v34 offset:13824
  ds_read_b64_tr_b16 v[12:13], v34 offset:12416
  ds_read_b64_tr_b16 v[14:15], v34 offset:13952
  ds_read_b64_tr_b16 v[16:17], v34 offset:12544
  ds_read_b64_tr_b16 v[18:19], v34 offset:14080
  s_waitcnt lgkmcnt(7)
  v_mfma_f32_32x32x16_bf16 v[96:111], v[52:55], v[44:47], v[96:111]
  v_mfma_f32_32x32x16_bf16 v[112:127], v[56:59], v[44:47], v[112:127]
  v_mfma_f32_32x32x16_bf16 v[128:143], v[44:47], v[60:63], v[128:143]
  ds_read_b128 v[44:47], v30 offset:3264
  ds_read_b64_tr_b16 v[52:53], v34 offset:18432
  ds_read_b64_tr_b16 v[54:55], v34 offset:19968
  ds_read_b64_tr_b16 v[56:57], v34 offset:18560
  ds_read_b64_tr_b16 v[58:59], v34 offset:20096
  ds_read_b64_tr_b16 v[60:61], v34 offset:18688
  ds_read_b64_tr_b16 v[62:63], v34 offset:20224
  s_waitcnt lgkmcnt(7)
  v_mfma_f32_32x32x16_bf16 v[96:111], v[8:11], v[40:43], v[96:111]
  v_mfma_f32_32x32x16_bf16 v[112:127], v[12:15], v[40:43], v[112:127]
  v_mfma_f32_32x32x16_bf16 v[128:143], v[40:43], v[16:19], v[128:143]
  s_waitcnt lgkmcnt(0)
  s_add_u32 s74, s73, 4
  s_and_b32 s74, s74, 7
  s_mul_i32 s74, s74, 4352
  v_add_u32 v34, 94208, v28
  v_add_u32 v30, s74, v24
  s_barrier
  ds_read_b128 v[40:43], v30 offset:0
  ds_read_b64_tr_b16 v[8:9], v34 offset:0
  ds_read_b64_tr_b16 v[10:11], v34 offset:1536
  ds_read_b64_tr_b16 v[12:13], v34 offset:128
  ds_read_b64_tr_b16 v[14:15], v34 offset:1664
  ds_read_b64_tr_b16 v[16:17], v34 offset:256
  ds_read_b64_tr_b16 v[18:19], v34 offset:1792
  v_mfma_f32_32x32x16_bf16 v[96:111], v[52:55], v[44:47], v[96:111]
  v_mfma_f32_32x32x16_bf16 v[112:127], v[56:59], v[44:47], v[112:127]
  v_mfma_f32_32x32x16_bf16 v[128:143], v[44:47], v[60:63], v[128:143]
  ds_read_b128 v[44:47], v30 offset:1088
  ds_read_b64_tr_b16 v[52:53], v34 offset:6144
  ds_read_b64_tr_b16 v[54:55], v34 offset:7680
  ds_read_b64_tr_b16 v[56:57], v34 offset:6272
  ds_read_b64_tr_b16 v[58:59], v34 offset:7808
  ds_read_b64_tr_b16 v[60:61], v34 offset:6400
  ds_read_b64_tr_b16 v[62:63], v34 offset:7936
  s_waitcnt lgkmcnt(7)
  v_mfma_f32_32x32x16_bf16 v[96:111], v[8:11], v[40:43], v[96:111]
  v_mfma_f32_32x32x16_bf16 v[112:127], v[12:15], v[40:43], v[112:127]
  v_mfma_f32_32x32x16_bf16 v[128:143], v[40:43], v[16:19], v[128:143]
  ds_read_b128 v[40:43], v30 offset:2176
  ds_read_b64_tr_b16 v[8:9], v34 offset:12288
  ds_read_b64_tr_b16 v[10:11], v34 offset:13824
  ds_read_b64_tr_b16 v[12:13], v34 offset:12416
  ds_read_b64_tr_b16 v[14:15], v34 offset:13952
  ds_read_b64_tr_b16 v[16:17], v34 offset:12544
  ds_read_b64_tr_b16 v[18:19], v34 offset:14080
  s_waitcnt lgkmcnt(7)
  v_mfma_f32_32x32x16_bf16 v[96:111], v[52:55], v[44:47], v[96:111]
  v_mfma_f32_32x32x16_bf16 v[112:127], v[56:59], v[44:47], v[112:127]
  v_mfma_f32_32x32x16_bf16 v[128:143], v[44:47], v[60:63], v[128:143]
  ds_read_b128 v[44:47], v30 offset:3264
  ds_read_b64_tr_b16 v[52:53], v34 offset:18432
  ds_read_b64_tr_b16 v[54:55], v34 offset:19968
  ds_read_b64_tr_b16 v[56:57], v34 offset:18560
  ds_read_b64_tr_b16 v[58:59], v34 offset:20096
  ds_read_b64_tr_b16 v[60:61], v34 offset:18688
  ds_read_b64_tr_b16 v[62:63], v34 offset:20224
  s_waitcnt lgkmcnt(7)
  v_mfma_f32_32x32x16_bf16 v[96:111], v[8:11], v[40:43], v[96:111]
  v_mfma_f32_32x32x16_bf16 v[112:127], v[12:15], v[40:43], v[112:127]
  v_mfma_f32_32x32x16_bf16 v[128:143], v[40:43], v[16:19], v[128:143]
  s_waitcnt lgkmcnt(0)
  s_add_u32 s74, s73, 5
  s_and_b32 s74, s74, 7
  s_mul_i32 s74, s74, 4352
  v_add_u32 v34, 118784, v28
  v_add_u32 v30, s74, v24
  s_barrier
  ds_read_b128 v[40:43], v30 offset:0
  ds_read_b64_tr_b16 v[8:9], v34 offset:0
  ds_read_b64_tr_b16 v[10:11], v34 offset:1536
  ds_read_b64_tr_b16 v[12:13], v34 offset:128
  ds_read_b64_tr_b16 v[14:15], v34 offset:1664
  ds_read_b64_tr_b16 v[16:17], v34 offset:256
  ds_read_b64_tr_b16 v[18:19], v34 offset:1792
  v_mfma_f32_32x32x16_bf16 v[96:111], v[52:55], v[44:47], v[96:111]
  v_mfma_f32_32x32x16_bf16 v[112:127], v[56:59], v[44:47], v[112:127]
  v_mfma_f32_32x32x16_bf16 v[128:143], v[44:47], v[60:63], v[128:143]
  ds_read_b128 v[44:47], v30 offset:1088
  ds_read_b64_tr_b16 v[52:53], v34 offset:6144
  ds_read_b64_tr_b16 v[54:55], v34 offset:7680
  ds_read_b64_tr_b16 v[56:57], v34 offset:6272
  ds_read_b64_tr_b16 v[58:59], v34 offset:7808
  ds_read_b64_tr_b16 v[60:61], v34 offset:6400
  ds_read_b64_tr_b16 v[62:63], v34 offset:7936
  s_waitcnt lgkmcnt(7)
  v_mfma_f32_32x32x16_bf16 v[96:111], v[8:11], v[40:43], v[96:111]
  v_mfma_f32_32x32x16_bf16 v[112:127], v[12:15], v[40:43], v[112:127]
  v_mfma_f32_32x32x16_bf16 v[128:143], v[40:43], v[16:19], v[128:143]
  ds_read_b128 v[40:43], v30 offset:2176
  ds_read_b64_tr_b16 v[8:9], v34 offset:12288
  ds_read_b64_tr_b16 v[10:11], v34 offset:13824
  ds_read_b64_tr_b16 v[12:13], v34 offset:12416
  ds_read_b64_tr_b16 v[14:15], v34 offset:13952
  ds_read_b64_tr_b16 v[16:17], v34 offset:12544
  ds_read_b64_tr_b16 v[18:19], v34 offset:14080
  s_waitcnt lgkmcnt(7)
  v_mfma_f32_32x32x16_bf16 v[96:111], v[52:55], v[44:47], v[96:111]
  v_mfma_f32_32x32x16_bf16 v[112:127], v[56:59], v[44:47], v[112:127]
  v_mfma_f32_32x32x16_bf16 v[128:143], v[44:47], v[60:63], v[128:143]
  ds_read_b128 v[44:47], v30 offset:3264
  ds_read_b64_tr_b16 v[52:53], v34 offset:18432
  ds_read_b64_tr_b16 v[54:55], v34 offset:19968
  ds_read_b64_tr_b16 v[56:57], v34 offset:18560
  ds_read_b64_tr_b16 v[58:59], v34 offset:20096
  ds_read_b64_tr_b16 v[60:61], v34 offset:18688
  ds_read_b64_tr_b16 v[62:63], v34 offset:20224
  s_waitcnt lgkmcnt(7)
  v_mfma_f32_32x32x16_bf16 v[96:111], v[8:11], v[40:43], v[96:111]
  v_mfma_f32_32x32x16_bf16 v[112:127], v[12:15], v[40:43], v[112:127]
  v_mfma_f32_32x32x16_bf16 v[128:143], v[40:43], v[16:19], v[128:143]
  s_waitcnt lgkmcnt(0)
  s_add_u32 s74, s73, 6
  s_and_b32 s74, s74, 7
  s_mul_i32 s74, s74, 4352
  v_add_u32 v34, 69632, v28
  v_add_u32 v30, s74, v24
  s_barrier
  ds_read_b128 v[40:43], v30 offset:0
  ds_read_b64_tr_b16 v[8:9], v34 offset:0
  ds_read_b64_tr_b16 v[10:11], v34 offset:1536
  ds_read_b64_tr_b16 v[12:13], v34 offset:128
  ds_read_b64_tr_b16 v[14:15], v34 offset:1664
  ds_read_b64_tr_b16 v[16:17], v34 offset:256
  ds_read_b64_tr_b16 v[18:19], v34 offset:1792
  v_mfma_f32_32x32x16_bf16 v[96:111], v[52:55], v[44:47], v[96:111]
  v_mfma_f32_32x32x16_bf16 v[112:127], v[56:59], v[44:47], v[112:127]
  v_mfma_f32_32x32x16_bf16 v[128:143], v[44:47], v[60:63], v[128:143]
  ds_read_b128 v[44:47], v30 offset:1088
  ds_read_b64_tr_b16 v[52:53], v34 offset:6144
  ds_read_b64_tr_b16 v[54:55], v34 offset:7680
  ds_read_b64_tr_b16 v[56:57], v34 offset:6272
  ds_read_b64_tr_b16 v[58:59], v34 offset:7808
  ds_read_b64_tr_b16 v[60:61], v34 offset:6400
  ds_read_b64_tr_b16 v[62:63], v34 offset:7936
  s_waitcnt lgkmcnt(7)
  v_mfma_f32_32x32x16_bf16 v[96:111], v[8:11], v[40:43], v[96:111]
  v_mfma_f32_32x32x16_bf16 v[112:127], v[12:15], v[40:43], v[112:127]
  v_mfma_f32_32x32x16_bf16 v[128:143], v[40:43], v[16:19], v[128:143]
  ds_read_b128 v[40:43], v30 offset:2176
  ds_read_b64_tr_b16 v[8:9], v34 offset:12288
  ds_read_b64_tr_b16 v[10:11], v34 offset:13824
  ds_read_b64_tr_b16 v[12:13], v34 offset:12416
  ds_read_b64_tr_b16 v[14:15], v34 offset:13952
  ds_read_b64_tr_b16 v[16:17], v34 offset:12544
  ds_read_b64_tr_b16 v[18:19], v34 offset:14080
  s_waitcnt lgkmcnt(7)
  v_mfma_f32_32x32x16_bf16 v[96:111], v[52:55], v[44:47], v[96:111]
  v_mfma_f32_32x32x16_bf16 v[112:127], v[56:59], v[44:47], v[112:127]
  v_mfma_f32_32x32x16_bf16 v[128:143], v[44:47], v[60:63], v[128:143]
  ds_read_b128 v[44:47], v30 offset:3264
  ds_read_b64_tr_b16 v[52:53], v34 offset:18432
  ds_read_b64_tr_b16 v[54:55], v34 offset:19968
  ds_read_b64_tr_b16 v[56:57], v34 offset:18560
  ds_read_b64_tr_b16 v[58:59], v34 offset:20096
  ds_read_b64_tr_b16 v[60:61], v34 offset:18688
  ds_read_b64_tr_b16 v[62:63], v34 offset:20224
  s_waitcnt lgkmcnt(7)
  v_mfma_f32_32x32x16_bf16 v[96:111], v[8:11], v[40:43], v[96:111]
  v_mfma_f32_32x32x16_bf16 v[112:127], v[12:15], v[40:43], v[112:127]
  v_mfma_f32_32x32x16_bf16 v[128:143], v[40:43], v[16:19], v[128:143]
  s_waitcnt lgkmcnt(0)
  s_add_u32 s74, s73, 7
  s_and_b32 s74, s74, 7
  s_mul_i32 s74, s74, 4352
  v_add_u32 v34, 94208, v28
  v_add_u32 v30, s74, v24
  s_barrier
  ds_read_b128 v[40:43], v30 offset:0
  ds_read_b64_tr_b16 v[8:9], v34 offset:0
  ds_read_b64_tr_b16 v[10:11], v34 offset:1536
  ds_read_b64_tr_b16 v[12:13], v34 offset:128
  ds_read_b64_tr_b16 v[14:15], v34 offset:1664
  ds_read_b64_tr_b16 v[16:17], v34 offset:256
  ds_read_b64_tr_b16 v[18:19], v34 offset:1792
  v_mfma_f32_32x32x16_bf16 v[96:111], v[52:55], v[44:47], v[96:111]
  v_mfma_f32_32x32x16_bf16 v[112:127], v[56:59], v[44:47], v[112:127]
  v_mfma_f32_32x32x16_bf16 v[128:143], v[44:47], v[60:63], v[128:143]
  ds_read_b128 v[44:47], v30 offset:1088
  ds_read_b64_tr_b16 v[52:53], v34 offset:6144
  ds_read_b64_tr_b16 v[54:55], v34 offset:7680
  ds_read_b64_tr_b16 v[56:57], v34 offset:6272
  ds_read_b64_tr_b16 v[58:59], v34 offset:7808
  ds_read_b64_tr_b16 v[60:61], v34 offset:6400
  ds_read_b64_tr_b16 v[62:63], v34 offset:7936
  s_waitcnt lgkmcnt(7)
  v_mfma_f32_32x32x16_bf16 v[96:111], v[8:11], v[40:43], v[96:111]
  v_mfma_f32_32x32x16_bf16 v[112:127], v[12:15], v[40:43], v[112:127]
  v_mfma_f32_32x32x16_bf16 v[128:143], v[40:43], v[16:19], v[128:143]
  ds_read_b128 v[40:43], v30 offset:2176
  ds_read_b64_tr_b16 v[8:9], v34 offset:12288
  ds_read_b64_tr_b16 v[10:11], v34 offset:13824
  ds_read_b64_tr_b16 v[12:13], v34 offset:12416
  ds_read_b64_tr_b16 v[14:15], v34 offset:13952
  ds_read_b64_tr_b16 v[16:17], v34 offset:12544
  ds_read_b64_tr_b16 v[18:19], v34 offset:14080
  s_waitcnt lgkmcnt(7)
  v_mfma_f32_32x32x16_bf16 v[96:111], v[52:55], v[44:47], v[96:111]
  v_mfma_f32_32x32x16_bf16 v[112:127], v[56:59], v[44:47], v[112:127]
  v_mfma_f32_32x32x16_bf16 v[128:143], v[44:47], v[60:63], v[128:143]
  ds_read_b128 v[44:47], v30 offset:3264
  ds_read_b64_tr_b16 v[52:53], v34 offset:18432
  ds_read_b64_tr_b16 v[54:55], v34 offset:19968
  ds_read_b64_tr_b16 v[56:57], v34 offset:18560
  ds_read_b64_tr_b16 v[58:59], v34 offset:20096
  ds_read_b64_tr_b16 v[60:61], v34 offset:18688
  ds_read_b64_tr_b16 v[62:63], v34 offset:20224
  s_waitcnt lgkmcnt(7)
  v_mfma_f32_32x32x16_bf16 v[96:111], v[8:11], v[40:43], v[96:111]
  v_mfma_f32_32x32x16_bf16 v[112:127], v[12:15], v[40:43], v[112:127]
  v_mfma_f32_32x32x16_bf16 v[128:143], v[40:43], v[16:19], v[128:143]
  s_waitcnt lgkmcnt(0)
  v_mfma_f32_32x32x16_bf16 v[96:111], v[52:55], v[44:47], v[96:111]
  v_mfma_f32_32x32x16_bf16 v[112:127], v[56:59], v[44:47], v[112:127]
  v_mfma_f32_32x32x16_bf16 v[128:143], v[44:47], v[60:63], v[128:143]
  s_lshl_b32 s54, s43, 1
  s_add_u32 s54, s54, s46
  s_lshl_b32 s55, s44, 1
  s_add_u32 s55, s55, s48
  s_lshl_b32 s55, s55, 17
  s_lshl_b32 s56, s54, 10
  s_add_u32 s55, s55, s56
  s_add_u32 s56, s55, 0x10000
  s_add_u32 s57, s55, 2097152
  s_add_u32 s58, s56, 2097152
  s_mov_b32 s59, 0x3eb8aa3b
  v_and_b32 v11, 0x33, v1
  v_bfe_u32 v13, v1, 2, 1
  v_lshl_or_b32 v11, v13, 3, v11
  v_bfe_u32 v13, v1, 3, 1
  v_lshl_or_b32 v11, v13, 2, v11
  v_lshlrev_b32 v11, 4, v11
  v_and_b32 v12, 15, v1
  v_lshrrev_b32 v13, 5, v1
  v_lshl_add_u32 v12, v13, 4, v12
  v_lshlrev_b32 v12, 4, v12
  v_bfe_u32 v13, v1, 4, 1
  v_lshl_add_u32 v12, v13, 16, v12
  v_mul_f32 v96, s59, v96
  v_mul_f32 v97, s59, v97
  v_mul_f32 v98, s59, v98
  v_mul_f32 v99, s59, v99
  v_mul_f32 v100, s59, v100
  v_mul_f32 v101, s59, v101
  v_mul_f32 v102, s59, v102
  v_mul_f32 v103, s59, v103
  v_mul_f32 v104, s59, v104
  v_mul_f32 v105, s59, v105
  v_mul_f32 v106, s59, v106
  v_mul_f32 v107, s59, v107
  v_mul_f32 v108, s59, v108
  v_mul_f32 v109, s59, v109
  v_mul_f32 v110, s59, v110
  v_mul_f32 v111, s59, v111
  v_cvt_pk_bf16_f32 v96, v96, v97
  v_cvt_pk_bf16_f32 v97, v98, v99
  v_cvt_pk_bf16_f32 v98, v100, v101
  v_cvt_pk_bf16_f32 v99, v102, v103
  v_cvt_pk_bf16_f32 v100, v104, v105
  v_cvt_pk_bf16_f32 v101, v106, v107
  v_cvt_pk_bf16_f32 v102, v108, v109
  v_cvt_pk_bf16_f32 v103, v110, v111
  buffer_store_dwordx4 v[96:99], v2, s[36:39], s55 offen
  buffer_store_dwordx4 v[100:103], v2, s[36:39], s56 offen
  v_cvt_pk_bf16_f32 v112, v112, v113
  v_cvt_pk_bf16_f32 v113, v114, v115
  v_cvt_pk_bf16_f32 v114, v116, v117
  v_cvt_pk_bf16_f32 v115, v118, v119
  v_cvt_pk_bf16_f32 v116, v120, v121
  v_cvt_pk_bf16_f32 v117, v122, v123
  v_cvt_pk_bf16_f32 v118, v124, v125
  v_cvt_pk_bf16_f32 v119, v126, v127
  buffer_store_dwordx4 v[112:115], v11, s[36:39], s57 offen
  buffer_store_dwordx4 v[116:119], v11, s[36:39], s58 offen
  s_add_u32 s55, s55, 4194304
  v_cvt_pk_bf16_f32 v128, v128, v129
  v_cvt_pk_bf16_f32 v129, v130, v131
  v_cvt_pk_bf16_f32 v130, v132, v133
  v_cvt_pk_bf16_f32 v131, v134, v135
  v_cvt_pk_bf16_f32 v132, v136, v137
  v_cvt_pk_bf16_f32 v133, v138, v139
  v_cvt_pk_bf16_f32 v134, v140, v141
  v_cvt_pk_bf16_f32 v135, v142, v143
  buffer_store_dwordx4 v[128:131], v12, s[36:39], s55 offen
  buffer_store_dwordx4 v[132:135], v12, s[36:39], s55 offen offset:512
  s_endpgm
k1_kernel_help:
  s_sub_u32 s42, s42, 4
  s_mov_b32 s28, s6
  s_mov_b32 s29, s7
  s_mov_b32 s30, 0x180000
  s_mov_b32 s31, 0x20000
  s_mov_b32 s46, 0xAAAB
  s_mul_i32 s45, s42, 49152
  s_lshl_b32 s48, s44, 7
  s_mul_i32 s50, s42, 6144
  s_add_u32 s50, s50, 69632
  v_add_u32 v16, 0, v1
  v_mul_lo_u32 v17, v16, s46
  v_lshrrev_b32 v17, 20, v17
  v_mul_u32_u24 v18, 24, v17
  v_sub_u32 v18, v16, v18
  v_lshrrev_b32 v19, 2, v18
  v_bfe_u32 v16, v17, 1, 1
  v_xor_b32 v19, v19, v16
  v_mul_u32_u24 v17, 0xc00, v17
  v_lshrrev_b32 v16, 1, v19
  v_lshl_add_u32 v17, v16, 10, v17
  v_and_b32 v19, 1, v19
  v_lshl_add_u32 v17, v19, 6, v17
  v_and_b32 v18, 3, v18
  v_lshl_add_u32 v17, v18, 4, v17
  v_add_u32 v20, s45, v17
  v_add_u32 v23, 0x6000, v20
  v_add_u32 v16, 64, v1
  v_mul_lo_u32 v17, v16, s46
  v_lshrrev_b32 v17, 20, v17
  v_mul_u32_u24 v18, 24, v17
  v_sub_u32 v18, v16, v18
  v_lshrrev_b32 v19, 2, v18
  v_bfe_u32 v16, v17, 1, 1
  v_xor_b32 v19, v19, v16
  v_mul_u32_u24 v17, 0xc00, v17
  v_lshrrev_b32 v16, 1, v19
  v_lshl_add_u32 v17, v16, 10, v17
  v_and_b32 v19, 1, v19
  v_lshl_add_u32 v17, v19, 6, v17
  v_and_b32 v18, 3, v18
  v_lshl_add_u32 v17, v18, 4, v17
  v_add_u32 v21, s45, v17
  v_add_u32 v24, 0x6000, v21
  v_add_u32 v16, 128, v1
  v_mul_lo_u32 v17, v16, s46
  v_lshrrev_b32 v17, 20, v17
  v_mul_u32_u24 v18, 24, v17
  v_sub_u32 v18, v16, v18
  v_lshrrev_b32 v19, 2, v18
  v_bfe_u32 v16, v17, 1, 1
  v_xor_b32 v19, v19, v16
  v_mul_u32_u24 v17, 0xc00, v17
  v_lshrrev_b32 v16, 1, v19
  v_lshl_add_u32 v17, v16, 10, v17
  v_and_b32 v19, 1, v19
  v_lshl_add_u32 v17, v19, 6, v17
  v_and_b32 v18, 3, v18
  v_lshl_add_u32 v17, v18, 4, v17
  v_add_u32 v22, s45, v17
  v_add_u32 v25, 0x6000, v22
  v_mov_b32 v48, 0
  v_mov_b32 v49, 0
  v_mov_b32 v50, 0
  v_mov_b32 v51, 0
  s_waitcnt vmcnt(7)
  v_lshlrev_b32 v96, 16, v64
  v_and_b32 v97, v36, v64
  v_add_f32 v48, v48, v96
  v_add_f32 v49, v49, v97
  v_fmac_f32 v50, v96, v96
  v_fmac_f32 v51, v97, v97
  v_lshlrev_b32 v98, 16, v65
  v_and_b32 v99, v36, v65
  v_add_f32 v48, v48, v98
  v_add_f32 v49, v49, v99
  v_fmac_f32 v50, v98, v98
  v_fmac_f32 v51, v99, v99
  v_lshlrev_b32 v100, 16, v66
  v_and_b32 v101, v36, v66
  v_add_f32 v48, v48, v100
  v_add_f32 v49, v49, v101
  v_fmac_f32 v50, v100, v100
  v_fmac_f32 v51, v101, v101
  v_lshlrev_b32 v102, 16, v67
  v_and_b32 v103, v36, v67
  v_add_f32 v48, v48, v102
  v_add_f32 v49, v49, v103
  v_fmac_f32 v50, v102, v102
  v_fmac_f32 v51, v103, v103
  s_waitcnt vmcnt(6)
  v_lshlrev_b32 v104, 16, v68
  v_and_b32 v105, v36, v68
  v_add_f32 v48, v48, v104
  v_add_f32 v49, v49, v105
  v_fmac_f32 v50, v104, v104
  v_fmac_f32 v51, v105, v105
  v_lshlrev_b32 v106, 16, v69
  v_and_b32 v107, v36, v69
  v_add_f32 v48, v48, v106
  v_add_f32 v49, v49, v107
  v_fmac_f32 v50, v106, v106
  v_fmac_f32 v51, v107, v107
  v_lshlrev_b32 v108, 16, v70
  v_and_b32 v109, v36, v70
  v_add_f32 v48, v48, v108
  v_add_f32 v49, v49, v109
  v_fmac_f32 v50, v108, v108
  v_fmac_f32 v51, v109, v109
  v_lshlrev_b32 v110, 16, v71
  v_and_b32 v111, v36, v71
  v_add_f32 v48, v48, v110
  v_add_f32 v49, v49, v111
  v_fmac_f32 v50, v110, v110
  v_fmac_f32 v51, v111, v111
  s_waitcnt vmcnt(5)
  s_add_u32 s74, s73, 0
  s_and_b32 s74, s74, 7
  s_mul_i32 s74, s74, 196608
  s_add_u32 s51, s48, s74
  s_add_u32 m0, s50, 0
  s_nop 0
  buffer_load_dwordx4 v20, s[28:31], s51 offen lds
  s_add_u32 m0, s50, 1024
  s_nop 0
  buffer_load_dwordx4 v21, s[28:31], s51 offen lds
  v_lshlrev_b32 v112, 16, v72
  v_and_b32 v113, v36, v72
  v_add_f32 v48, v48, v112
  v_add_f32 v49, v49, v113
  v_fmac_f32 v50, v112, v112
  v_fmac_f32 v51, v113, v113
  v_lshlrev_b32 v114, 16, v73
  v_and_b32 v115, v36, v73
  v_add_f32 v48, v48, v114
  v_add_f32 v49, v49, v115
  v_fmac_f32 v50, v114, v114
  v_fmac_f32 v51, v115, v115
  v_lshlrev_b32 v116, 16, v74
  v_and_b32 v117, v36, v74
  v_add_f32 v48, v48, v116
  v_add_f32 v49, v49, v117
  v_fmac_f32 v50, v116, v116
  v_fmac_f32 v51, v117, v117
  v_lshlrev_b32 v118, 16, v75
  v_and_b32 v119, v36, v75
  v_add_f32 v48, v48, v118
  v_add_f32 v49, v49, v119
  v_fmac_f32 v50, v118, v118
  v_fmac_f32 v51, v119, v119
  s_waitcnt vmcnt(6)
  s_add_u32 m0, s50, 2048
  s_nop 0
  buffer_load_dwordx4 v22, s[28:31], s51 offen lds
  s_add_u32 m0, s50, 3072
  s_nop 0
  buffer_load_dwordx4 v23, s[28:31], s51 offen lds
  v_lshlrev_b32 v120, 16, v76
  v_and_b32 v121, v36, v76
  v_add_f32 v48, v48, v120
  v_add_f32 v49, v49, v121
  v_fmac_f32 v50, v120, v120
  v_fmac_f32 v51, v121, v121
  v_lshlrev_b32 v122, 16, v77
  v_and_b32 v123, v36, v77
  v_add_f32 v48, v48, v122
  v_add_f32 v49, v49, v123
  v_fmac_f32 v50, v122, v122
  v_fmac_f32 v51, v123, v123
  v_lshlrev_b32 v124, 16, v78
  v_and_b32 v125, v36, v78
  v_add_f32 v48, v48, v124
  v_add_f32 v49, v49, v125
  v_fmac_f32 v50, v124, v124
  v_fmac_f32 v51, v125, v125
  v_lshlrev_b32 v126, 16, v79
  v_and_b32 v127, v36, v79
  v_add_f32 v48, v48, v126
  v_add_f32 v49, v49, v127
  v_fmac_f32 v50, v126, v126
  v_fmac_f32 v51, v127, v127
  s_waitcnt vmcnt(7)
  s_add_u32 m0, s50, 4096
  s_nop 0
  buffer_load_dwordx4 v24, s[28:31], s51 offen lds
  s_add_u32 m0, s50, 5120
  s_nop 0
  buffer_load_dwordx4 v25, s[28:31], s51 offen lds
  v_lshlrev_b32 v128, 16, v80
  v_and_b32 v129, v36, v80
  v_add_f32 v48, v48, v128
  v_add_f32 v49, v49, v129
  v_fmac_f32 v50, v128, v128
  v_fmac_f32 v51, v129, v129
  v_lshlrev_b32 v130, 16, v81
  v_and_b32 v131, v36, v81
  v_add_f32 v48, v48, v130
  v_add_f32 v49, v49, v131
  v_fmac_f32 v50, v130, v130
  v_fmac_f32 v51, v131, v131
  v_lshlrev_b32 v132, 16, v82
  v_and_b32 v133, v36, v82
  v_add_f32 v48, v48, v132
  v_add_f32 v49, v49, v133
  v_fmac_f32 v50, v132, v132
  v_fmac_f32 v51, v133, v133
  v_lshlrev_b32 v134, 16, v83
  v_and_b32 v135, v36, v83
  v_add_f32 v48, v48, v134
  v_add_f32 v49, v49, v135
  v_fmac_f32 v50, v134, v134
  v_fmac_f32 v51, v135, v135
  s_waitcnt vmcnt(8)
  s_add_u32 s74, s73, 1
  s_and_b32 s74, s74, 7
  s_mul_i32 s74, s74, 196608
  s_add_u32 s51, s48, s74
  s_add_u32 m0, s50, 24576
  s_nop 0
  buffer_load_dwordx4 v20, s[28:31], s51 offen lds
  s_add_u32 m0, s50, 25600
  s_nop 0
  buffer_load_dwordx4 v21, s[28:31], s51 offen lds
  v_lshlrev_b32 v136, 16, v84
  v_and_b32 v137, v36, v84
  v_add_f32 v48, v48, v136
  v_add_f32 v49, v49, v137
  v_fmac_f32 v50, v136, v136
  v_fmac_f32 v51, v137, v137
  v_lshlrev_b32 v138, 16, v85
  v_and_b32 v139, v36, v85
  v_add_f32 v48, v48, v138
  v_add_f32 v49, v49, v139
  v_fmac_f32 v50, v138, v138
  v_fmac_f32 v51, v139, v139
  v_lshlrev_b32 v140, 16, v86
  v_and_b32 v141, v36, v86
  v_add_f32 v48, v48, v140
  v_add_f32 v49, v49, v141
  v_fmac_f32 v50, v140, v140
  v_fmac_f32 v51, v141, v141
  v_lshlrev_b32 v142, 16, v87
  v_and_b32 v143, v36, v87
  v_add_f32 v48, v48, v142
  v_add_f32 v49, v49, v143
  v_fmac_f32 v50, v142, v142
  v_fmac_f32 v51, v143, v143
  s_waitcnt vmcnt(9)
  s_add_u32 m0, s50, 26624
  s_nop 0
  buffer_load_dwordx4 v22, s[28:31], s51 offen lds
  s_add_u32 m0, s50, 27648
  s_nop 0
  buffer_load_dwordx4 v23, s[28:31], s51 offen lds
  v_lshlrev_b32 v144, 16, v88
  v_and_b32 v145, v36, v88
  v_add_f32 v48, v48, v144
  v_add_f32 v49, v49, v145
  v_fmac_f32 v50, v144, v144
  v_fmac_f32 v51, v145, v145
  v_lshlrev_b32 v146, 16, v89
  v_and_b32 v147, v36, v89
  v_add_f32 v48, v48, v146
  v_add_f32 v49, v49, v147
  v_fmac_f32 v50, v146, v146
  v_fmac_f32 v51, v147, v147
  v_lshlrev_b32 v148, 16, v90
  v_and_b32 v149, v36, v90
  v_add_f32 v48, v48, v148
  v_add_f32 v49, v49, v149
  v_fmac_f32 v50, v148, v148
  v_fmac_f32 v51, v149, v149
  v_lshlrev_b32 v150, 16, v91
  v_and_b32 v151, v36, v91
  v_add_f32 v48, v48, v150
  v_add_f32 v49, v49, v151
  v_fmac_f32 v50, v150, v150
  v_fmac_f32 v51, v151, v151
  s_waitcnt vmcnt(10)
  s_add_u32 m0, s50, 28672
  s_nop 0
  buffer_load_dwordx4 v24, s[28:31], s51 offen lds
  s_add_u32 m0, s50, 29696
  s_nop 0
  buffer_load_dwordx4 v25, s[28:31], s51 offen lds
  v_lshlrev_b32 v152, 16, v92
  v_and_b32 v153, v36, v92
  v_add_f32 v48, v48, v152
  v_add_f32 v49, v49, v153
  v_fmac_f32 v50, v152, v152
  v_fmac_f32 v51, v153, v153
  v_lshlrev_b32 v154, 16, v93
  v_and_b32 v155, v36, v93
  v_add_f32 v48, v48, v154
  v_add_f32 v49, v49, v155
  v_fmac_f32 v50, v154, v154
  v_fmac_f32 v51, v155, v155
  v_lshlrev_b32 v156, 16, v94
  v_and_b32 v157, v36, v94
  v_add_f32 v48, v48, v156
  v_add_f32 v49, v49, v157
  v_fmac_f32 v50, v156, v156
  v_fmac_f32 v51, v157, v157
  v_lshlrev_b32 v158, 16, v95
  v_and_b32 v159, v36, v95
  v_add_f32 v48, v48, v158
  v_add_f32 v49, v49, v159
  v_fmac_f32 v50, v158, v158
  v_fmac_f32 v51, v159, v159
  v_add_f32 v48, v48, v49
  v_add_f32 v50, v50, v51
  s_nop 1
  v_add_f32_dpp v48, v48, v48 quad_perm:[1,0,3,2] row_mask:0xf bank_mask:0xf
  v_add_f32_dpp v50, v50, v50 quad_perm:[1,0,3,2] row_mask:0xf bank_mask:0xf
  s_nop 1
  v_add_f32_dpp v48, v48, v48 quad_perm:[2,3,0,1] row_mask:0xf bank_mask:0xf
  v_add_f32_dpp v50, v50, v50 quad_perm:[2,3,0,1] row_mask:0xf bank_mask:0xf
  s_nop 1
  v_add_f32_dpp v48, v48, v48 row_half_mirror row_mask:0xf bank_mask:0xf
  v_add_f32_dpp v50, v50, v50 row_half_mirror row_mask:0xf bank_mask:0xf
  s_nop 1
  v_mul_f32 v48, 0x3b000000, v48
  v_mul_f32 v50, 0x3b000000, v50
  v_fma_f32 v50, -v48, v48, v50
  v_max_f32 v50, 0, v50
  v_add_f32 v50, 0x3727c5ac, v50
  v_rsq_f32 v49, v50
  s_nop 0
  v_mul_f32 v50, v48, v49
  v_sub_f32 v50, 0, v50
  v_fma_f32 v96, v96, v49, v50
  v_fma_f32 v97, v97, v49, v50
  v_fma_f32 v98, v98, v49, v50
  v_fma_f32 v99, v99, v49, v50
  v_fma_f32 v100, v100, v49, v50
  v_fma_f32 v101, v101, v49, v50
  v_fma_f32 v102, v102, v49, v50
  v_fma_f32 v103, v103, v49, v50
  v_cvt_pk_bf16_f32 v64, v96, v97
  v_cvt_pk_bf16_f32 v65, v98, v99
  v_cvt_pk_bf16_f32 v66, v100, v101
  v_cvt_pk_bf16_f32 v67, v102, v103
  ds_write_b128 v6, v[64:67] offset:0
  v_fma_f32 v104, v104, v49, v50
  v_fma_f32 v105, v105, v49, v50
  v_fma_f32 v106, v106, v49, v50
  v_fma_f32 v107, v107, v49, v50
  v_fma_f32 v108, v108, v49, v50
  v_fma_f32 v109, v109, v49, v50
  v_fma_f32 v110, v110, v49, v50
  v_fma_f32 v111, v111, v49, v50
  v_cvt_pk_bf16_f32 v68, v104, v105
  v_cvt_pk_bf16_f32 v69, v106, v107
  v_cvt_pk_bf16_f32 v70, v108, v109
  v_cvt_pk_bf16_f32 v71, v110, v111
  ds_write_b128 v6, v[68:71] offset:4352
  v_fma_f32 v112, v112, v49, v50
  v_fma_f32 v113, v113, v49, v50
  v_fma_f32 v114, v114, v49, v50
  v_fma_f32 v115, v115, v49, v50
  v_fma_f32 v116, v116, v49, v50
  v_fma_f32 v117, v117, v49, v50
  v_fma_f32 v118, v118, v49, v50
  v_fma_f32 v119, v119, v49, v50
  v_cvt_pk_bf16_f32 v72, v112, v113
  v_cvt_pk_bf16_f32 v73, v114, v115
  v_cvt_pk_bf16_f32 v74, v116, v117
  v_cvt_pk_bf16_f32 v75, v118, v119
  ds_write_b128 v6, v[72:75] offset:8704
  v_fma_f32 v120, v120, v49, v50
  v_fma_f32 v121, v121, v49, v50
  v_fma_f32 v122, v122, v49, v50
  v_fma_f32 v123, v123, v49, v50
  v_fma_f32 v124, v124, v49, v50
  v_fma_f32 v125, v125, v49, v50
  v_fma_f32 v126, v126, v49, v50
  v_fma_f32 v127, v127, v49, v50
  v_cvt_pk_bf16_f32 v76, v120, v121
  v_cvt_pk_bf16_f32 v77, v122, v123
  v_cvt_pk_bf16_f32 v78, v124, v125
  v_cvt_pk_bf16_f32 v79, v126, v127
  ds_write_b128 v6, v[76:79] offset:13056
  v_fma_f32 v128, v128, v49, v50
  v_fma_f32 v129, v129, v49, v50
  v_fma_f32 v130, v130, v49, v50
  v_fma_f32 v131, v131, v49, v50
  v_fma_f32 v132, v132, v49, v50
  v_fma_f32 v133, v133, v49, v50
  v_fma_f32 v134, v134, v49, v50
  v_fma_f32 v135, v135, v49, v50
  v_cvt_pk_bf16_f32 v80, v128, v129
  v_cvt_pk_bf16_f32 v81, v130, v131
  v_cvt_pk_bf16_f32 v82, v132, v133
  v_cvt_pk_bf16_f32 v83, v134, v135
  ds_write_b128 v6, v[80:83] offset:17408
  v_fma_f32 v136, v136, v49, v50
  v_fma_f32 v137, v137, v49, v50
  v_fma_f32 v138, v138, v49, v50
  v_fma_f32 v139, v139, v49, v50
  v_fma_f32 v140, v140, v49, v50
  v_fma_f32 v141, v141, v49, v50
  v_fma_f32 v142, v142, v49, v50
  v_fma_f32 v143, v143, v49, v50
  v_cvt_pk_bf16_f32 v84, v136, v137
  v_cvt_pk_bf16_f32 v85, v138, v139
  v_cvt_pk_bf16_f32 v86, v140, v141
  v_cvt_pk_bf16_f32 v87, v142, v143
  ds_write_b128 v6, v[84:87] offset:21760
  v_fma_f32 v144, v144, v49, v50
  v_fma_f32 v145, v145, v49, v50
  v_fma_f32 v146, v146, v49, v50
  v_fma_f32 v147, v147, v49, v50
  v_fma_f32 v148, v148, v49, v50
  v_fma_f32 v149, v149, v49, v50
  v_fma_f32 v150, v150, v49, v50
  v_fma_f32 v151, v151, v49, v50
  v_cvt_pk_bf16_f32 v88, v144, v145
  v_cvt_pk_bf16_f32 v89, v146, v147
  v_cvt_pk_bf16_f32 v90, v148, v149
  v_cvt_pk_bf16_f32 v91, v150, v151
  ds_write_b128 v6, v[88:91] offset:26112
  v_fma_f32 v152, v152, v49, v50
  v_fma_f32 v153, v153, v49, v50
  v_fma_f32 v154, v154, v49, v50
  v_fma_f32 v155, v155, v49, v50
  v_fma_f32 v156, v156, v49, v50
  v_fma_f32 v157, v157, v49, v50
  v_fma_f32 v158, v158, v49, v50
  v_fma_f32 v159, v159, v49, v50
  v_cvt_pk_bf16_f32 v92, v152, v153
  v_cvt_pk_bf16_f32 v93, v154, v155
  v_cvt_pk_bf16_f32 v94, v156, v157
  v_cvt_pk_bf16_f32 v95, v158, v159
  ds_write_b128 v6, v[92:95] offset:30464
  s_waitcnt vmcnt(6) lgkmcnt(0)
  s_barrier
  s_add_u32 s74, s73, 2
  s_and_b32 s74, s74, 7
  s_mul_i32 s74, s74, 196608
  s_add_u32 s51, s48, s74
  s_add_u32 m0, s50, 49152
  s_nop 0
  buffer_load_dwordx4 v20, s[28:31], s51 offen lds
  s_add_u32 m0, s50, 50176
  s_nop 0
  buffer_load_dwordx4 v21, s[28:31], s51 offen lds
  s_add_u32 m0, s50, 51200
  s_nop 0
  buffer_load_dwordx4 v22, s[28:31], s51 offen lds
  s_add_u32 m0, s50, 52224
  s_nop 0
  buffer_load_dwordx4 v23, s[28:31], s51 offen lds
  s_add_u32 m0, s50, 53248
  s_nop 0
  buffer_load_dwordx4 v24, s[28:31], s51 offen lds
  s_add_u32 m0, s50, 54272
  s_nop 0
  buffer_load_dwordx4 v25, s[28:31], s51 offen lds
  s_waitcnt vmcnt(6)
  s_barrier
  s_add_u32 s74, s73, 3
  s_and_b32 s74, s74, 7
  s_mul_i32 s74, s74, 196608
  s_add_u32 s51, s48, s74
  s_add_u32 m0, s50, 0
  s_nop 0
  buffer_load_dwordx4 v20, s[28:31], s51 offen lds
  s_add_u32 m0, s50, 1024
  s_nop 0
  buffer_load_dwordx4 v21, s[28:31], s51 offen lds
  s_add_u32 m0, s50, 2048
  s_nop 0
  buffer_load_dwordx4 v22, s[28:31], s51 offen lds
  s_add_u32 m0, s50, 3072
  s_nop 0
  buffer_load_dwordx4 v23, s[28:31], s51 offen lds
  s_add_u32 m0, s50, 4096
  s_nop 0
  buffer_load_dwordx4 v24, s[28:31], s51 offen lds
  s_add_u32 m0, s50, 5120
  s_nop 0
  buffer_load_dwordx4 v25, s[28:31], s51 offen lds
  s_waitcnt vmcnt(6)
  s_barrier
  s_add_u32 s74, s73, 4
  s_and_b32 s74, s74, 7
  s_mul_i32 s74, s74, 196608
  s_add_u32 s51, s48, s74
  s_add_u32 m0, s50, 24576
  s_nop 0
  buffer_load_dwordx4 v20, s[28:31], s51 offen lds
  s_add_u32 m0, s50, 25600
  s_nop 0
  buffer_load_dwordx4 v21, s[28:31], s51 offen lds
  s_add_u32 m0, s50, 26624
  s_nop 0
  buffer_load_dwordx4 v22, s[28:31], s51 offen lds
  s_add_u32 m0, s50, 27648
  s_nop 0
  buffer_load_dwordx4 v23, s[28:31], s51 offen lds
  s_add_u32 m0, s50, 28672
  s_nop 0
  buffer_load_dwordx4 v24, s[28:31], s51 offen lds
  s_add_u32 m0, s50, 29696
  s_nop 0
  buffer_load_dwordx4 v25, s[28:31], s51 offen lds
  s_waitcnt vmcnt(6)
  s_barrier
  s_add_u32 s74, s73, 5
  s_and_b32 s74, s74, 7
  s_mul_i32 s74, s74, 196608
  s_add_u32 s51, s48, s74
  s_add_u32 m0, s50, 49152
  s_nop 0
  buffer_load_dwordx4 v20, s[28:31], s51 offen lds
  s_add_u32 m0, s50, 50176
  s_nop 0
  buffer_load_dwordx4 v21, s[28:31], s51 offen lds
  s_add_u32 m0, s50, 51200
  s_nop 0
  buffer_load_dwordx4 v22, s[28:31], s51 offen lds
  s_add_u32 m0, s50, 52224
  s_nop 0
  buffer_load_dwordx4 v23, s[28:31], s51 offen lds
  s_add_u32 m0, s50, 53248
  s_nop 0
  buffer_load_dwordx4 v24, s[28:31], s51 offen lds
  s_add_u32 m0, s50, 54272
  s_nop 0
  buffer_load_dwordx4 v25, s[28:31], s51 offen lds
  s_waitcnt vmcnt(6)
  s_barrier
  s_add_u32 s74, s73, 6
  s_and_b32 s74, s74, 7
  s_mul_i32 s74, s74, 196608
  s_add_u32 s51, s48, s74
  s_add_u32 m0, s50, 0
  s_nop 0
  buffer_load_dwordx4 v20, s[28:31], s51 offen lds
  s_add_u32 m0, s50, 1024
  s_nop 0
  buffer_load_dwordx4 v21, s[28:31], s51 offen lds
  s_add_u32 m0, s50, 2048
  s_nop 0
  buffer_load_dwordx4 v22, s[28:31], s51 offen lds
  s_add_u32 m0, s50, 3072
  s_nop 0
  buffer_load_dwordx4 v23, s[28:31], s51 offen lds
  s_add_u32 m0, s50, 4096
  s_nop 0
  buffer_load_dwordx4 v24, s[28:31], s51 offen lds
  s_add_u32 m0, s50, 5120
  s_nop 0
  buffer_load_dwordx4 v25, s[28:31], s51 offen lds
  s_waitcnt vmcnt(6)
  s_barrier
  s_add_u32 s74, s73, 7
  s_and_b32 s74, s74, 7
  s_mul_i32 s74, s74, 196608
  s_add_u32 s51, s48, s74
  s_add_u32 m0, s50, 24576
  s_nop 0
  buffer_load_dwordx4 v20, s[28:31], s51 offen lds
  s_add_u32 m0, s50, 25600
  s_nop 0
  buffer_load_dwordx4 v21, s[28:31], s51 offen lds
  s_add_u32 m0, s50, 26624
  s_nop 0
  buffer_load_dwordx4 v22, s[28:31], s51 offen lds
  s_add_u32 m0, s50, 27648
  s_nop 0
  buffer_load_dwordx4 v23, s[28:31], s51 offen lds
  s_add_u32 m0, s50, 28672
  s_nop 0
  buffer_load_dwordx4 v24, s[28:31], s51 offen lds
  s_add_u32 m0, s50, 29696
  s_nop 0
  buffer_load_dwordx4 v25, s[28:31], s51 offen lds
  s_waitcnt vmcnt(6)
  s_barrier
  s_waitcnt vmcnt(0)
  s_barrier
  s_endpgm
k1_kernel_idle:
  v_lshlrev_b32 v2, 4, v1
  s_sub_u32 s42, s42, 8
  s_waitcnt lgkmcnt(0)
  s_mov_b32 s36, s20
  s_mov_b32 s37, s21
  s_mov_b32 s38, 0x1a00000
  s_mov_b32 s39, 0x20000
  s_lshl_b32 s52, s2, 2
  s_add_u32 s52, s52, s42
  v_lshrrev_b32 v14, 2, v1
  v_and_b32 v15, 3, v1
  v_lshlrev_b32 v15, 4, v15
  v_mul_u32_u24 v14, 2752, v14
  v_add_u32 v26, v14, v15
  s_mul_i32 s53, s42, 3072
  s_add_u32 s53, s53, 143360
  s_mov_b32 s32, s12
  s_mov_b32 s33, s13
  s_mov_b32 s34, 0x158000
  s_mov_b32 s35, 0x20000
  s_mov_b32 s8, s14
  s_mov_b32 s9, s15
  s_mov_b32 s10, 0x158000
  s_mov_b32 s11, 0x20000
  s_add_u32 s54, s52, 0
  s_min_u32 s54, s54, 2751
  s_cmp_ge_u32 s54, 1376
  s_cselect_b32 s55, 1, 0
  s_mul_i32 s56, s55, 1376
  s_sub_u32 s56, s54, s56
  s_mul_i32 s57, s56, 6097
  s_lshr_b32 s57, s57, 18
  s_mul_i32 s58, s57, 43
  s_sub_u32 s58, s56, s58
  s_mul_i32 s56, s57, 44032
  s_lshl_b32 s70, s58, 6
  s_add_u32 s64, s56, s70
  s_lshl_b32 s70, s58, 16
  s_lshl_b32 s57, s57, 11
  s_add_u32 s70, s70, s57
  s_mov_b32 s67, s55
  s_lshl_b32 s55, s55, 10
  s_add_u32 s70, s70, s55
  s_add_u32 s60, s70, 10485760
  s_add_u32 s54, s52, 1024
  s_min_u32 s54, s54, 2751
  s_cmp_ge_u32 s54, 1376
  s_cselect_b32 s55, 1, 0
  s_mul_i32 s56, s55, 1376
  s_sub_u32 s56, s54, s56
  s_mul_i32 s57, s56, 6097
  s_lshr_b32 s57, s57, 18
  s_mul_i32 s58, s57, 43
  s_sub_u32 s58, s56, s58
  s_mul_i32 s56, s57, 44032
  s_lshl_b32 s70, s58, 6
  s_add_u32 s65, s56, s70
  s_lshl_b32 s70, s58, 16
  s_lshl_b32 s57, s57, 11
  s_add_u32 s70, s70, s57
  s_mov_b32 s68, s55
  s_lshl_b32 s55, s55, 10
  s_add_u32 s70, s70, s55
  s_add_u32 s61, s70, 10485760
  s_add_u32 s54, s52, 2048
  s_min_u32 s54, s54, 2751
  s_cmp_ge_u32 s54, 1376
  s_cselect_b32 s55, 1, 0
  s_mul_i32 s56, s55, 1376
  s_sub_u32 s56, s54, s56
  s_mul_i32 s57, s56, 6097
  s_lshr_b32 s57, s57, 18
  s_mul_i32 s58, s57, 43
  s_sub_u32 s58, s56, s58
  s_mul_i32 s56, s57, 44032
  s_lshl_b32 s70, s58, 6
  s_add_u32 s66, s56, s70
  s_lshl_b32 s70, s58, 16
  s_lshl_b32 s57, s57, 11
  s_add_u32 s70, s70, s57
  s_mov_b32 s69, s55
  s_lshl_b32 s55, s55, 10
  s_add_u32 s70, s70, s55
  s_add_u32 s62, s70, 10485760
  s_barrier
  s_lshr_b32 s46, s42, 1
  s_and_b32 s47, s42, 1
  s_lshl_b32 s47, s47, 1
  s_lshl_b32 s77, s44, 2
  s_add_u32 s47, s47, s77
  s_mul_i32 s77, s46, 34816
  s_mul_i32 s76, s47, 1088
  s_add_u32 s77, s77, s76
  v_and_b32 v16, 31, v1
  v_lshrrev_b32 v17, 5, v1
  v_mul_u32_u24 v17, 544, v17
  v_lshl_add_u32 v17, v16, 4, v17
  v_add_u32 v17, s77, v17
  ds_read_b128 v[64:67], v17
  ds_read_b128 v[68:71], v17 offset:1088
  s_lshl_b32 s77, s43, 1
  s_add_u32 s77, s77, s46
  s_lshl_b32 s77, s77, 15
  s_lshl_b32 s47, s47, 10
  s_add_u32 s77, s77, s47
  s_add_u32 s49, s77, 6291456
  v_lshlrev_b32 v2, 4, v1
  s_waitcnt lgkmcnt(0)
  buffer_store_dwordx4 v[64:67], v2, s[36:39], s49 offen nt
  buffer_store_dwordx4 v[68:71], v2, s[36:39], s49 offen offset:1024 nt
  s_lshl_b32 s49, s2, 5
  s_add_u32 s49, s49, 0x1800000
  v_lshlrev_b32 v16, 2, v1
  v_mov_b32 v17, 0
  s_mov_b64 exec, 0xff
  buffer_store_dword v17, v16, s[36:39], s49 offen nt
  s_mov_b64 exec, -1
  s_barrier
  s_barrier
  s_barrier
  s_barrier
  s_barrier
  s_add_u32 m0, s53, 0
  s_cmp_eq_u32 s67, 0
  s_cbranch_scc1 L_fm_1
  buffer_load_dwordx4 v26, s[8:11], s64 offen lds
  s_branch L_fm_1x
L_fm_1:
  buffer_load_dwordx4 v26, s[32:35], s64 offen lds
L_fm_1x:
  s_add_u32 m0, s53, 1024
  s_cmp_eq_u32 s68, 0
  s_cbranch_scc1 L_fm_2
  buffer_load_dwordx4 v26, s[8:11], s65 offen lds
  s_branch L_fm_2x
L_fm_2:
  buffer_load_dwordx4 v26, s[32:35], s65 offen lds
L_fm_2x:
  s_add_u32 m0, s53, 2048
  s_cmp_eq_u32 s69, 0
  s_cbranch_scc1 L_fm_3
  buffer_load_dwordx4 v26, s[8:11], s66 offen lds
  s_branch L_fm_3x
L_fm_3:
  buffer_load_dwordx4 v26, s[32:35], s66 offen lds
L_fm_3x:
  s_waitcnt lgkmcnt(0)
  s_lshl_b32 s52, s2, 2
  s_add_u32 s52, s52, s42
  v_lshrrev_b32 v4, 5, v1
  v_and_b32 v5, 31, v1
  v_lshlrev_b32 v5, 1, v5
  v_lshl_add_u32 v4, v4, 12, v5
  v_add_u32 v5, 0x2000, v4
  s_mov_b32 s79, 0x20000
  s_add_u32 s55, s52, 0
  s_min_u32 s55, s55, 1887
  s_mov_b32 s78, 1409024
  s_mov_b32 s71, 88064
  s_mov_b32 s72, 13631488
  s_cmp_ge_u32 s55, 1376
  s_cselect_b32 s76, s22, s16
  s_cselect_b32 s77, s23, s17
  s_cselect_b32 s78, 524288, s78
  s_cselect_b32 s56, 1376, 0
  s_cselect_b32 s71, 32768, s71
  s_cselect_b32 s72, 15728640, s72
  s_sub_u32 s55, s55, s56
  s_lshr_b32 s57, s55, 4
  s_and_b32 s58, s55, 15
  s_lshl_b32 s56, s57, 14
  s_lshl_b32 s70, s58, 6
  s_add_u32 s56, s56, s70
  s_mul_i32 s70, s58, s71
  s_lshl_b32 s57, s57, 10
  s_add_u32 s70, s70, s57
  s_add_u32 s74, s70, s72
  buffer_load_ushort v128, v4, s[76:79], s56 offen offset:0
  buffer_load_ushort v129, v4, s[76:79], s56 offen offset:1024
  buffer_load_ushort v130, v4, s[76:79], s56 offen offset:2048
  buffer_load_ushort v131, v4, s[76:79], s56 offen offset:3072
  buffer_load_ushort v132, v5, s[76:79], s56 offen offset:0
  buffer_load_ushort v133, v5, s[76:79], s56 offen offset:1024
  buffer_load_ushort v134, v5, s[76:79], s56 offen offset:2048
  buffer_load_ushort v135, v5, s[76:79], s56 offen offset:3072
  s_add_u32 s55, s52, 1024
  s_min_u32 s55, s55, 1887
  s_mov_b32 s78, 1409024
  s_mov_b32 s71, 88064
  s_mov_b32 s72, 13631488
  s_cmp_ge_u32 s55, 1376
  s_cselect_b32 s76, s22, s16
  s_cselect_b32 s77, s23, s17
  s_cselect_b32 s78, 524288, s78
  s_cselect_b32 s56, 1376, 0
  s_cselect_b32 s71, 32768, s71
  s_cselect_b32 s72, 15728640, s72
  s_sub_u32 s55, s55, s56
  s_lshr_b32 s57, s55, 4
  s_and_b32 s58, s55, 15
  s_lshl_b32 s56, s57, 14
  s_lshl_b32 s70, s58, 6
  s_add_u32 s56, s56, s70
  s_mul_i32 s70, s58, s71
  s_lshl_b32 s57, s57, 10
  s_add_u32 s70, s70, s57
  s_add_u32 s75, s70, s72
  buffer_load_ushort v136, v4, s[76:79], s56 offen offset:0
  buffer_load_ushort v137, v4, s[76:79], s56 offen offset:1024
  buffer_load_ushort v138, v4, s[76:79], s56 offen offset:2048
  buffer_load_ushort v139, v4, s[76:79], s56 offen offset:3072
  buffer_load_ushort v140, v5, s[76:79], s56 offen offset:0
  buffer_load_ushort v141, v5, s[76:79], s56 offen offset:1024
  buffer_load_ushort v142, v5, s[76:79], s56 offen offset:2048
  buffer_load_ushort v143, v5, s[76:79], s56 offen offset:3072
  s_barrier
  s_barrier
  s_waitcnt vmcnt(0)
  v_bfe_u32 v13, v1, 2, 2
  v_bfe_u32 v14, v1, 4, 1
  v_lshlrev_b32 v13, 6, v13
  v_lshl_add_u32 v13, v14, 5, v13
  v_and_b32 v14, 3, v1
  v_lshl_add_u32 v13, v14, 3, v13
  v_lshrrev_b32 v14, 5, v1
  v_lshl_add_u32 v13, v14, 9, v13
  v_add_u32 v13, s53, v13
  ds_read_b64_tr_b16 v[112:113], v13 offset:0
  ds_read_b64_tr_b16 v[114:115], v13 offset:256
  ds_read_b64_tr_b16 v[116:117], v13 offset:1024
  ds_read_b64_tr_b16 v[118:119], v13 offset:1280
  ds_read_b64_tr_b16 v[120:121], v13 offset:2048
  ds_read_b64_tr_b16 v[122:123], v13 offset:2304
  s_waitcnt lgkmcnt(4)
  buffer_store_dwordx4 v[112:115], v2, s[36:39], s60 offen nt
  s_waitcnt lgkmcnt(2)
  buffer_store_dwordx4 v[116:119], v2, s[36:39], s61 offen nt
  s_waitcnt lgkmcnt(0)
  buffer_store_dwordx4 v[120:123], v2, s[36:39], s62 offen nt
  s_waitcnt vmcnt(63)
  v_lshl_or_b32 v128, v129, 16, v128
  v_lshl_or_b32 v129, v131, 16, v130
  v_lshl_or_b32 v130, v133, 16, v132
  v_lshl_or_b32 v131, v135, 16, v134
  buffer_store_dwordx4 v[128:131], v2, s[36:39], s74 offen nt
  v_lshl_or_b32 v136, v137, 16, v136
  v_lshl_or_b32 v137, v139, 16, v138
  v_lshl_or_b32 v138, v141, 16, v140
  v_lshl_or_b32 v139, v143, 16, v142
  buffer_store_dwordx4 v[136:139], v2, s[36:39], s75 offen nt
  s_add_u32 s42, s42, 8
k1_kernel_end:
  s_endpgm
.text
.globl k2_kernel
.p2align 8
.type k2_kernel,@function
k2_kernel:
  s_cmp_ge_u32 s2, 256
  s_cbranch_scc1 k2_kernel_end
  s_load_dwordx2 s[20:21], s[0:1], 72
  v_and_b32 v1, 63, v0
  v_lshrrev_b32 v2, 6, v0
  s_and_b32 s40, s2, 7
  s_lshr_b32 s41, s2, 3
  v_readfirstlane_b32 s42, v2
  s_waitcnt lgkmcnt(0)
  s_cmp_ge_u32 s42, 8
  s_cbranch_scc1 k2_kernel_ffn
  s_mov_b32 s24, s20
  s_mov_b32 s25, s21
  s_mov_b32 s26, 0x1a00000
  s_mov_b32 s27, 0x20000
  s_lshl_b32 s43, s40, 2
  s_lshr_b32 s44, s41, 3
  s_add_u32 s43, s43, s44
  s_and_b32 s44, s41, 7
  s_lshl_b32 s44, s44, 3
  s_add_u32 s44, s44, s42
  v_lshlrev_b32 v4, 4, v1
  s_lshl_b32 s46, s43, 16
  s_lshl_b32 s47, s44, 10
  s_add_u32 s47, s47, s46
  s_add_u32 s48, s46, 2097152
  buffer_load_dwordx4 v[8:11], v4, s[24:27], s47 offen
  s_add_u32 s49, s46, 4194304
  s_mul_i32 s50, s42, 2048
  s_add_u32 s51, s50, 0
  s_add_u32 m0, s51, 0
  s_add_u32 s51, s51, s48
  buffer_load_dwordx4 v4, s[24:27], s51 offen offset:0 lds
  buffer_load_dwordx4 v4, s[24:27], s51 offen offset:1024 lds
  s_add_u32 s51, s50, 0
  s_add_u32 m0, s51, 65536
  s_add_u32 s51, s51, s49
  buffer_load_dwordx4 v4, s[24:27], s51 offen offset:0 lds
  buffer_load_dwordx4 v4, s[24:27], s51 offen offset:1024 lds
  s_mul_i32 s50, s42, 2048
  s_add_u32 s51, s50, 16384
  s_add_u32 m0, s51, 0
  s_add_u32 s51, s51, s48
  buffer_load_dwordx4 v4, s[24:27], s51 offen offset:0 lds
  buffer_load_dwordx4 v4, s[24:27], s51 offen offset:1024 lds
  s_add_u32 s51, s50, 16384
  s_add_u32 m0, s51, 65536
  s_add_u32 s51, s51, s49
  buffer_load_dwordx4 v4, s[24:27], s51 offen offset:0 lds
  buffer_load_dwordx4 v4, s[24:27], s51 offen offset:1024 lds
  v_mov_b32 v3, 0xdddd
  v_and_b32 v5, 15, v1
  v_lshrrev_b32 v6, 5, v1
  v_lshl_add_u32 v5, v6, 4, v5
  v_lshlrev_b32 v5, 4, v5
  v_add_u32 v5, 0x10000, v5
  s_mov_b32 s52, 0x0000ffff
  s_mov_b32 s53, 0x0000ffff
  s_mov_b32 s54, 0
  s_mov_b32 s57, 7
  s_mov_b32 s61, 51200
  s_setprio 2
  s_mov_b32 s58, 34
  s_mov_b32 s59, 136
  v_mov_b32 v135, 0x20000
  v_mov_b32 v136, 0
  v_mov_b32 v137, 0
  ds_write_b64 v135, v[136:137]
  ds_write_b64 v135, v[136:137] offset:8
  v_mov_b32 v20, 0x3f803f80
  v_mov_b32 v21, 0x3f803f80
  v_mov_b32 v22, 0x3f803f80
  v_mov_b32 v23, 0x3f803f80
  v_mov_b32 v24, 0x3f803f80
  v_mov_b32 v25, 0x3f803f80
  v_mov_b32 v26, 0x3f803f80
  v_mov_b32 v27, 0x3f803f80
  v_mov_b32 v28, 0x3f803f80
  v_mov_b32 v29, 0x3f803f80
  v_mov_b32 v30, 0x3f803f80
  v_mov_b32 v31, 0x3f803f80
  v_mov_b32 v32, 0x3f803f80
  v_mov_b32 v33, 0x3f803f80
  v_mov_b32 v34, 0x3f803f80
  v_mov_b32 v35, 0x3f803f80
  s_waitcnt vmcnt(4) lgkmcnt(0)
  v_mov_b32 v136, 1
  s_barrier
  ds_read_b128 v[12:15], v4
  s_waitcnt lgkmcnt(0)
  v_mfma_f32_32x32x16_bf16 v[68:83], v[12:15], v[8:11], 0
  s_nop 11
  v_max_f32 v6, v68, v69
  v_max3_f32 v6, v70, v71, v6
  v_max3_f32 v6, v72, v73, v6
  v_max3_f32 v6, v74, v75, v6
  v_max3_f32 v6, v76, v77, v6
  v_max3_f32 v6, v78, v79, v6
  v_max3_f32 v6, v80, v81, v6
  v_max3_f32 v6, v82, v83, v6
  v_mov_b32 v133, v6
  s_nop 1
  v_permlane32_swap_b32 v6, v133
  s_nop 1
  v_max_f32 v6, v6, v133
  v_sub_f32 v6, 0xc2a00000, v6
k2_kernel_restart:
  ds_read_b128 v[12:15], v4
  ds_read_b128 v[16:19], v4 offset:1024
  v_mov_b32 v36, v6
  v_mov_b32 v37, v6
  v_mov_b32 v38, v6
  v_mov_b32 v39, v6
  v_mov_b32 v40, v6
  v_mov_b32 v41, v6
  v_mov_b32 v42, v6
  v_mov_b32 v43, v6
  v_mov_b32 v44, v6
  v_mov_b32 v45, v6
  v_mov_b32 v46, v6
  v_mov_b32 v47, v6
  v_mov_b32 v48, v6
  v_mov_b32 v49, v6
  v_mov_b32 v50, v6
  v_mov_b32 v51, v6
  v_mov_b32 v52, 0
  v_mov_b32 v53, 0
  v_mov_b32 v54, 0
  v_mov_b32 v55, 0
  v_mov_b32 v56, 0
  v_mov_b32 v57, 0
  v_mov_b32 v58, 0
  v_mov_b32 v59, 0
  v_mov_b32 v60, 0
  v_mov_b32 v61, 0
  v_mov_b32 v62, 0
  v_mov_b32 v63, 0
  v_mov_b32 v64, 0
  v_mov_b32 v65, 0
  v_mov_b32 v66, 0
  v_mov_b32 v67, 0
  v_mov_b32 v116, 0
  v_mov_b32 v117, 0
  v_mov_b32 v118, 0
  v_mov_b32 v119, 0
  v_mov_b32 v120, 0
  v_mov_b32 v121, 0
  v_mov_b32 v122, 0
  v_mov_b32 v123, 0
  v_mov_b32 v124, 0
  v_mov_b32 v125, 0
  v_mov_b32 v126, 0
  v_mov_b32 v127, 0
  v_mov_b32 v128, 0
  v_mov_b32 v129, 0
  v_mov_b32 v130, 0
  v_mov_b32 v131, 0
  v_mov_b32 v6, v4
  v_mov_b32 v7, v5
  s_mov_b32 s55, 0
  s_waitcnt lgkmcnt(0)
  v_mfma_f32_32x32x16_bf16 v[68:83], v[12:15], v[8:11], v[36:51]
  s_nop 7
.p2align 6
k2_kernel_loop:
  s_cmp_gt_u32 s55, s57
  s_cbranch_scc1 L_nob_1
  s_bitcmp1_b32 s58, s55
  s_cbranch_scc0 L_nob_1c
  s_waitcnt vmcnt(0)
  s_mov_b64 exec, 1
  ds_add_u32 v135, v136
  s_mov_b64 exec, -1
  s_cmp_eq_u32 s55, 1
  s_cbranch_scc0 L_nob_1
  s_mul_i32 s50, s42, 4096
  s_add_u32 s51, s50, 32768
  s_add_u32 m0, s51, 0
  s_add_u32 s51, s51, s48
  buffer_load_dwordx4 v4, s[24:27], s51 offen offset:0 lds
  buffer_load_dwordx4 v4, s[24:27], s51 offen offset:1024 lds
  buffer_load_dwordx4 v4, s[24:27], s51 offen offset:2048 lds
  buffer_load_dwordx4 v4, s[24:27], s51 offen offset:3072 lds
  s_add_u32 s51, s50, 32768
  s_add_u32 m0, s51, 65536
  s_add_u32 s51, s51, s49
  buffer_load_dwordx4 v4, s[24:27], s51 offen offset:0 lds
  buffer_load_dwordx4 v4, s[24:27], s51 offen offset:1024 lds
  buffer_load_dwordx4 v4, s[24:27], s51 offen offset:2048 lds
  buffer_load_dwordx4 v4, s[24:27], s51 offen offset:3072 lds
  s_branch L_nob_1
L_nob_1c:
  s_bitcmp1_b32 s59, s55
  s_cbranch_scc0 L_nob_1
  s_lshl_b32 s56, s55, 1
  s_add_u32 s56, s56, 2
L_nob_1s:
  ds_read_b32 v134, v135
  s_waitcnt lgkmcnt(0)
  v_readfirstlane_b32 s60, v134
  s_cmp_ge_u32 s60, s56
  s_cbranch_scc0 L_nob_1s
L_nob_1:
  s_waitcnt lgkmcnt(0)
  v_mfma_f32_32x32x16_bf16 v[84:99], v[16:19], v[8:11], v[36:51]
  ds_read_b128 v[12:15], v6 offset:2048
  s_mov_b64 exec, s[52:53]
  ds_read_b128 v[20:23], v7 offset:0
  ds_read_b128 v[24:27], v7 offset:512
  s_mov_b64 exec, -1
  v_exp_f32 v68, v68
  v_exp_f32 v69, v69
  v_exp_f32 v70, v70
  v_exp_f32 v71, v71
  v_exp_f32 v72, v72
  v_smfmac_f32_32x32x32_bf16 v[52:67], v[28:31], v[116:123], v3
  v_exp_f32 v73, v73
  v_exp_f32 v74, v74
  v_exp_f32 v75, v75
  v_exp_f32 v76, v76
  v_exp_f32 v77, v77
  v_smfmac_f32_32x32x32_bf16 v[52:67], v[32:35], v[124:131], v3
  v_exp_f32 v78, v78
  v_exp_f32 v79, v79
  v_exp_f32 v80, v80
  v_exp_f32 v81, v81
  v_exp_f32 v82, v82
  v_exp_f32 v83, v83
  s_waitcnt lgkmcnt(0)
  v_mfma_f32_32x32x16_bf16 v[100:115], v[12:15], v[8:11], v[36:51]
  ds_read_b128 v[16:19], v6 offset:3072
  s_mov_b64 exec, s[52:53]
  ds_read_b128 v[28:31], v7 offset:1024
  ds_read_b128 v[32:35], v7 offset:1536
  s_mov_b64 exec, -1
  v_exp_f32 v84, v84
  v_exp_f32 v85, v85
  v_exp_f32 v86, v86
  v_exp_f32 v87, v87
  v_exp_f32 v88, v88
  v_smfmac_f32_32x32x32_bf16 v[52:67], v[20:23], v[68:75], v3
  v_exp_f32 v89, v89
  v_exp_f32 v90, v90
  v_exp_f32 v91, v91
  v_exp_f32 v92, v92
  v_exp_f32 v93, v93
  v_smfmac_f32_32x32x32_bf16 v[52:67], v[24:27], v[76:83], v3
  v_exp_f32 v94, v94
  v_exp_f32 v95, v95
  v_exp_f32 v96, v96
  v_exp_f32 v97, v97
  v_exp_f32 v98, v98
  v_exp_f32 v99, v99
  s_waitcnt lgkmcnt(0)
  v_mfma_f32_32x32x16_bf16 v[116:131], v[16:19], v[8:11], v[36:51]
  ds_read_b128 v[12:15], v6 offset:4096
  s_mov_b64 exec, s[52:53]
  ds_read_b128 v[20:23], v7 offset:2048
  ds_read_b128 v[24:27], v7 offset:2560
  s_mov_b64 exec, -1
  v_exp_f32 v100, v100
  v_exp_f32 v101, v101
  v_exp_f32 v102, v102
  v_exp_f32 v103, v103
  v_exp_f32 v104, v104
  v_smfmac_f32_32x32x32_bf16 v[52:67], v[28:31], v[84:91], v3
  v_exp_f32 v105, v105
  v_exp_f32 v106, v106
  v_exp_f32 v107, v107
  v_exp_f32 v108, v108
  v_exp_f32 v109, v109
  v_smfmac_f32_32x32x32_bf16 v[52:67], v[32:35], v[92:99], v3
  v_exp_f32 v110, v110
  v_exp_f32 v111, v111
  v_exp_f32 v112, v112
  v_exp_f32 v113, v113
  v_exp_f32 v114, v114
  v_exp_f32 v115, v115
  s_waitcnt lgkmcnt(0)
  v_mfma_f32_32x32x16_bf16 v[68:83], v[12:15], v[8:11], v[36:51]
  ds_read_b128 v[16:19], v6 offset:5120
  s_mov_b64 exec, s[52:53]
  ds_read_b128 v[28:31], v7 offset:3072
  ds_read_b128 v[32:35], v7 offset:3584
  s_mov_b64 exec, -1
  v_exp_f32 v116, v116
  v_exp_f32 v117, v117
  v_exp_f32 v118, v118
  v_exp_f32 v119, v119
  v_exp_f32 v120, v120
  v_smfmac_f32_32x32x32_bf16 v[52:67], v[20:23], v[100:107], v3
  v_exp_f32 v121, v121
  v_exp_f32 v122, v122
  v_exp_f32 v123, v123
  v_exp_f32 v124, v124
  v_exp_f32 v125, v125
  v_smfmac_f32_32x32x32_bf16 v[52:67], v[24:27], v[108:115], v3
  v_exp_f32 v126, v126
  v_exp_f32 v127, v127
  v_exp_f32 v128, v128
  v_exp_f32 v129, v129
  v_exp_f32 v130, v130
  v_exp_f32 v131, v131
  v_add_u32 v6, 4096, v6
  v_add_u32 v7, 4096, v7
  s_add_u32 s55, s55, 1
  s_bitcmp1_b32 s61, s55
  s_cbranch_scc0 L_nob_1p
  s_setprio 2
  s_cmp_eq_u32 s55, 11
  s_cbranch_scc1 L_nob_1p
  s_setprio 1
  s_cmp_eq_u32 s55, 14
  s_cbranch_scc1 L_nob_1p
  s_setprio 0
L_nob_1p:
  s_cmp_lt_u32 s55, 16
  s_cbranch_scc1 k2_kernel_loop
  s_waitcnt lgkmcnt(0)
  v_smfmac_f32_32x32x32_bf16 v[52:67], v[28:31], v[116:123], v3
  v_smfmac_f32_32x32x32_bf16 v[52:67], v[32:35], v[124:131], v3
  s_nop 11
  s_cmp_eq_u32 s54, 0
  s_cbranch_scc0 k2_kernel_fin
  v_add_f32 v6, |v52|, v60
  v_add_f32 v6, |v53|, v6
  v_add_f32 v6, |v54|, v6
  v_add_f32 v6, |v55|, v6
  v_add_f32 v6, |v56|, v6
  v_add_f32 v6, |v57|, v6
  v_add_f32 v6, |v58|, v6
  v_add_f32 v6, |v59|, v6
  v_mov_b32 v7, 0x207
  v_cmp_class_f32 vcc, v6, v7
  s_nop 1
  s_cmp_eq_u64 vcc, 0
  s_cbranch_scc1 k2_kernel_fin
  s_mov_b32 s54, 1
  s_mov_b32 s58, 0
  s_mov_b32 s59, 0
  s_mov_b32 s55, 0
  v_mov_b32 v134, v4
  v_mov_b32 v6, 0xff800000
k2_kernel_mx:
  ds_read_b128 v[12:15], v134
  s_waitcnt lgkmcnt(0)
  v_mfma_f32_32x32x16_bf16 v[68:83], v[12:15], v[8:11], 0
  s_nop 11
  v_max3_f32 v6, v68, v69, v6
  v_max3_f32 v6, v70, v71, v6
  v_max3_f32 v6, v72, v73, v6
  v_max3_f32 v6, v74, v75, v6
  v_max3_f32 v6, v76, v77, v6
  v_max3_f32 v6, v78, v79, v6
  v_max3_f32 v6, v80, v81, v6
  v_max3_f32 v6, v82, v83, v6
  v_add_u32 v134, 1024, v134
  s_add_u32 s55, s55, 1
  s_cmp_lt_u32 s55, 64
  s_cbranch_scc1 k2_kernel_mx
  v_mov_b32 v133, v6
  s_nop 1
  v_permlane32_swap_b32 v6, v133
  s_nop 1
  v_max_f32 v6, v6, v133
  v_sub_f32 v6, 0, v6
  s_branch k2_kernel_restart
k2_kernel_fin:
  v_rcp_f32 v6, v60
  s_lshl_b32 s46, s44, 15
  s_lshl_b32 s47, s43, 10
  s_add_u32 s46, s46, s47
  s_add_u32 s46, s46, 8388608
  v_mul_f32 v52, v52, v6
  v_mul_f32 v53, v53, v6
  v_mul_f32 v54, v54, v6
  v_mul_f32 v55, v55, v6
  v_mul_f32 v56, v56, v6
  v_mul_f32 v57, v57, v6
  v_mul_f32 v58, v58, v6
  v_mul_f32 v59, v59, v6
  v_cvt_pk_bf16_f32 v52, v52, v53
  v_cvt_pk_bf16_f32 v53, v54, v55
  v_cvt_pk_bf16_f32 v54, v56, v57
  v_cvt_pk_bf16_f32 v55, v58, v59
  buffer_store_dwordx4 v[52:55], v4, s[24:27], s46 offen sc0 sc1
  s_and_b32 s46, s41, 7
  s_lshl_b32 s46, s46, 5
  s_add_u32 s46, s46, s43
  s_lshl_b32 s46, s46, 2
  s_add_u32 s46, s46, 25171968
  v_mov_b32 v7, 0
  s_mov_b64 exec, 1
  s_waitcnt vmcnt(0)
  ds_add_rtn_u32 v6, v135, v136 offset:8
  s_waitcnt lgkmcnt(0)
  v_readfirstlane_b32 s47, v6
  s_cmp_eq_u32 s47, 7
  s_cbranch_scc0 k2_kernel_ax
  buffer_store_dword v136, v7, s[24:27], s46 offen sc0 sc1
k2_kernel_ax:
  s_mov_b64 exec, -1
  s_endpgm
k2_kernel_ffn:
  s_sub_u32 s42, s42, 8
  s_load_dwordx2 s[16:17], s[0:1], 48
  s_load_dwordx2 s[8:9], s[0:1], 16
  s_lshl_b32 s43, s41, 2
  s_add_u32 s43, s43, s42
  s_mul_i32 s44, s43, 5958
  s_lshr_b32 s44, s44, 16
  s_mul_i32 s45, s44, 11
  s_sub_u32 s45, s43, s45
  s_lshr_b32 s46, s40, 1
  s_mul_i32 s46, s46, 11
  s_add_u32 s45, s45, s46
  v_lshlrev_b32 v3, 4, v1
  s_cmp_ge_u32 s44, 11
  s_cbranch_scc1 k2_kernel_idle
  s_cmp_ge_u32 s45, 43
  s_cbranch_scc1 k2_kernel_idle
  s_and_b32 s46, s40, 1
  s_mul_i32 s46, s46, 11
  s_add_u32 s44, s44, s46
  s_lshl_b32 s62, s44, 6
  s_add_u32 s62, s62, s45
  s_lshl_b32 s62, s62, 2
  s_add_u32 s62, s62, 25165824
  s_mul_i32 s44, s44, 3
  s_lshl_b32 s58, s44, 15
  s_lshl_b32 s46, s45, 16
  v_add_u32 v7, s46, v3
  v_add_u32 v4, s58, v3
  v_add_u32 v5, 0x8000, v4
  v_add_u32 v6, 0x10000, v4
  s_mov_b32 s47, 0
  s_mov_b32 s48, 0
  s_add_u32 s24, s20, 0x600000
  s_addc_u32 s25, s21, 0
  s_mov_b32 s26, 0x200000
  s_mov_b32 s27, 0x20000
  s_add_u32 s32, s20, 0x1000000
  s_addc_u32 s33, s21, 0
  s_mov_b32 s34, 0x560000
  s_mov_b32 s35, 0x20000
  s_add_u32 s28, s20, 0xa00000
  s_addc_u32 s29, s21, 0
  s_mov_b32 s30, 0x2b0000
  s_mov_b32 s31, 0x20000
  v_mov_b32 v8, 0
  v_mov_b32 v9, 0
  v_mov_b32 v10, 0
  v_mov_b32 v11, 0
  v_mov_b32 v12, 0
  v_mov_b32 v13, 0
  v_mov_b32 v14, 0
  v_mov_b32 v15, 0
  v_mov_b32 v16, 0
  v_mov_b32 v17, 0
  v_mov_b32 v18, 0
  v_mov_b32 v19, 0
  v_mov_b32 v20, 0
  v_mov_b32 v21, 0
  v_mov_b32 v22, 0
  v_mov_b32 v23, 0
  v_mov_b32 v24, 0
  v_mov_b32 v25, 0
  v_mov_b32 v26, 0
  v_mov_b32 v27, 0
  v_mov_b32 v28, 0
  v_mov_b32 v29, 0
  v_mov_b32 v30, 0
  v_mov_b32 v31, 0
  v_mov_b32 v32, 0
  v_mov_b32 v33, 0
  v_mov_b32 v34, 0
  v_mov_b32 v35, 0
  v_mov_b32 v36, 0
  v_mov_b32 v37, 0
  v_mov_b32 v38, 0
  v_mov_b32 v39, 0
  v_mov_b32 v40, 0
  v_mov_b32 v41, 0
  v_mov_b32 v42, 0
  v_mov_b32 v43, 0
  v_mov_b32 v44, 0
  v_mov_b32 v45, 0
  v_mov_b32 v46, 0
  v_mov_b32 v47, 0
  v_mov_b32 v48, 0
  v_mov_b32 v49, 0
  v_mov_b32 v50, 0
  v_mov_b32 v51, 0
  v_mov_b32 v52, 0
  v_mov_b32 v53, 0
  v_mov_b32 v54, 0
  v_mov_b32 v55, 0
  v_mov_b32 v56, 0
  v_mov_b32 v57, 0
  v_mov_b32 v58, 0
  v_mov_b32 v59, 0
  v_mov_b32 v60, 0
  v_mov_b32 v61, 0
  v_mov_b32 v62, 0
  v_mov_b32 v63, 0
  v_mov_b32 v64, 0
  v_mov_b32 v65, 0
  v_mov_b32 v66, 0
  v_mov_b32 v67, 0
  v_mov_b32 v68, 0
  v_mov_b32 v69, 0
  v_mov_b32 v70, 0
  v_mov_b32 v71, 0
  v_mov_b32 v72, 0
  v_mov_b32 v73, 0
  v_mov_b32 v74, 0
  v_mov_b32 v75, 0
  v_mov_b32 v76, 0
  v_mov_b32 v77, 0
  v_mov_b32 v78, 0
  v_mov_b32 v79, 0
  v_mov_b32 v80, 0
  v_mov_b32 v81, 0
  v_mov_b32 v82, 0
  v_mov_b32 v83, 0
  v_mov_b32 v84, 0
  v_mov_b32 v85, 0
  v_mov_b32 v86, 0
  v_mov_b32 v87, 0
  v_mov_b32 v88, 0
  v_mov_b32 v89, 0
  v_mov_b32 v90, 0
  v_mov_b32 v91, 0
  v_mov_b32 v92, 0
  v_mov_b32 v93, 0
  v_mov_b32 v94, 0
  v_mov_b32 v95, 0
  v_mov_b32 v96, 0
  v_mov_b32 v97, 0
  v_mov_b32 v98, 0
  v_mov_b32 v99, 0
  v_mov_b32 v100, 0
  v_mov_b32 v101, 0
  v_mov_b32 v102, 0
  v_mov_b32 v103, 0
  s_setprio 3
  s_barrier
  buffer_load_dwordx4 v[104:107], v7, s[28:31], s48 offen
  buffer_load_dwordx4 v[112:115], v4, s[24:27], s47 offen
  buffer_load_dwordx4 v[108:111], v7, s[28:31], s48 offen offset:1024
  s_add_u32 s48, s48, 2048
  buffer_load_dwordx4 v[116:119], v5, s[24:27], s47 offen
  buffer_load_dwordx4 v[120:123], v6, s[24:27], s47 offen
  s_add_u32 s47, s47, 1024
  buffer_load_dwordx4 v[124:127], v7, s[28:31], s48 offen
  buffer_load_dwordx4 v[132:135], v4, s[24:27], s47 offen
  buffer_load_dwordx4 v[128:131], v7, s[28:31], s48 offen offset:1024
  s_add_u32 s48, s48, 2048
  buffer_load_dwordx4 v[136:139], v5, s[24:27], s47 offen
  buffer_load_dwordx4 v[140:143], v6, s[24:27], s47 offen
  s_add_u32 s47, s47, 1024
  buffer_load_dwordx4 v[144:147], v7, s[28:31], s48 offen
  buffer_load_dwordx4 v[152:155], v4, s[24:27], s47 offen
  buffer_load_dwordx4 v[148:151], v7, s[28:31], s48 offen offset:1024
  s_add_u32 s48, s48, 2048
  buffer_load_dwordx4 v[156:159], v5, s[24:27], s47 offen
  buffer_load_dwordx4 v[160:163], v6, s[24:27], s47 offen
  s_add_u32 s47, s47, 1024
  s_mov_b32 s55, 0
k2_kernel_floop:
  s_waitcnt vmcnt(10)
  v_mfma_f32_32x32x16_bf16 v[8:23], v[104:107], v[112:115], v[8:23]
  s_nop 7
  v_mfma_f32_32x32x16_bf16 v[24:39], v[108:111], v[112:115], v[24:39]
  buffer_load_dwordx4 v[112:115], v4, s[24:27], s47 offen
  s_nop 7
  v_mfma_f32_32x32x16_bf16 v[40:55], v[104:107], v[116:119], v[40:55]
  s_nop 7
  v_mfma_f32_32x32x16_bf16 v[56:71], v[108:111], v[116:119], v[56:71]
  buffer_load_dwordx4 v[116:119], v5, s[24:27], s47 offen
  s_nop 7
  v_mfma_f32_32x32x16_bf16 v[72:87], v[104:107], v[120:123], v[72:87]
  buffer_load_dwordx4 v[104:107], v7, s[28:31], s48 offen
  s_nop 7
  v_mfma_f32_32x32x16_bf16 v[88:103], v[108:111], v[120:123], v[88:103]
  buffer_load_dwordx4 v[108:111], v7, s[28:31], s48 offen offset:1024
  buffer_load_dwordx4 v[120:123], v6, s[24:27], s47 offen
  s_add_u32 s48, s48, 2048
  s_add_u32 s47, s47, 1024
  s_waitcnt vmcnt(10)
  v_mfma_f32_32x32x16_bf16 v[8:23], v[124:127], v[132:135], v[8:23]
  s_nop 7
  v_mfma_f32_32x32x16_bf16 v[24:39], v[128:131], v[132:135], v[24:39]
  buffer_load_dwordx4 v[132:135], v4, s[24:27], s47 offen
  s_nop 7
  v_mfma_f32_32x32x16_bf16 v[40:55], v[124:127], v[136:139], v[40:55]
  s_nop 7
  v_mfma_f32_32x32x16_bf16 v[56:71], v[128:131], v[136:139], v[56:71]
  buffer_load_dwordx4 v[136:139], v5, s[24:27], s47 offen
  s_nop 7
  v_mfma_f32_32x32x16_bf16 v[72:87], v[124:127], v[140:143], v[72:87]
  buffer_load_dwordx4 v[124:127], v7, s[28:31], s48 offen
  s_nop 7
  v_mfma_f32_32x32x16_bf16 v[88:103], v[128:131], v[140:143], v[88:103]
  buffer_load_dwordx4 v[128:131], v7, s[28:31], s48 offen offset:1024
  buffer_load_dwordx4 v[140:143], v6, s[24:27], s47 offen
  s_add_u32 s48, s48, 2048
  s_add_u32 s47, s47, 1024
  s_waitcnt vmcnt(10)
  v_mfma_f32_32x32x16_bf16 v[8:23], v[144:147], v[152:155], v[8:23]
  s_nop 7
  v_mfma_f32_32x32x16_bf16 v[24:39], v[148:151], v[152:155], v[24:39]
  buffer_load_dwordx4 v[152:155], v4, s[24:27], s47 offen
  s_nop 7
  v_mfma_f32_32x32x16_bf16 v[40:55], v[144:147], v[156:159], v[40:55]
  s_nop 7
  v_mfma_f32_32x32x16_bf16 v[56:71], v[148:151], v[156:159], v[56:71]
  buffer_load_dwordx4 v[156:159], v5, s[24:27], s47 offen
  s_nop 7
  v_mfma_f32_32x32x16_bf16 v[72:87], v[144:147], v[160:163], v[72:87]
  buffer_load_dwordx4 v[144:147], v7, s[28:31], s48 offen
  s_nop 7
  v_mfma_f32_32x32x16_bf16 v[88:103], v[148:151], v[160:163], v[88:103]
  buffer_load_dwordx4 v[148:151], v7, s[28:31], s48 offen offset:1024
  buffer_load_dwordx4 v[160:163], v6, s[24:27], s47 offen
  s_add_u32 s48, s48, 2048
  s_add_u32 s47, s47, 1024
  s_add_u32 s55, s55, 1
  s_cmp_lt_u32 s55, 9
  s_cbranch_scc1 k2_kernel_floop
  s_waitcnt vmcnt(10)
  v_mfma_f32_32x32x16_bf16 v[8:23], v[104:107], v[112:115], v[8:23]
  v_mfma_f32_32x32x16_bf16 v[24:39], v[108:111], v[112:115], v[24:39]
  v_mfma_f32_32x32x16_bf16 v[40:55], v[104:107], v[116:119], v[40:55]
  v_mfma_f32_32x32x16_bf16 v[56:71], v[108:111], v[116:119], v[56:71]
  v_mfma_f32_32x32x16_bf16 v[72:87], v[104:107], v[120:123], v[72:87]
  v_mfma_f32_32x32x16_bf16 v[88:103], v[108:111], v[120:123], v[88:103]
  buffer_load_dwordx4 v[104:107], v7, s[28:31], s48 offen
  buffer_load_dwordx4 v[112:115], v4, s[24:27], s47 offen
  buffer_load_dwordx4 v[108:111], v7, s[28:31], s48 offen offset:1024
  s_add_u32 s48, s48, 2048
  buffer_load_dwordx4 v[116:119], v5, s[24:27], s47 offen
  buffer_load_dwordx4 v[120:123], v6, s[24:27], s47 offen
  s_add_u32 s47, s47, 1024
  s_waitcnt vmcnt(10)
  v_mfma_f32_32x32x16_bf16 v[8:23], v[124:127], v[132:135], v[8:23]
  v_mfma_f32_32x32x16_bf16 v[24:39], v[128:131], v[132:135], v[24:39]
  v_mfma_f32_32x32x16_bf16 v[40:55], v[124:127], v[136:139], v[40:55]
  v_mfma_f32_32x32x16_bf16 v[56:71], v[128:131], v[136:139], v[56:71]
  v_mfma_f32_32x32x16_bf16 v[72:87], v[124:127], v[140:143], v[72:87]
  v_mfma_f32_32x32x16_bf16 v[88:103], v[128:131], v[140:143], v[88:103]
  buffer_load_dwordx4 v[124:127], v7, s[28:31], s48 offen
  buffer_load_dwordx4 v[132:135], v4, s[24:27], s47 offen
  buffer_load_dwordx4 v[128:131], v7, s[28:31], s48 offen offset:1024
  s_add_u32 s48, s48, 2048
  buffer_load_dwordx4 v[136:139], v5, s[24:27], s47 offen
  buffer_load_dwordx4 v[140:143], v6, s[24:27], s47 offen
  s_add_u32 s47, s47, 1024
  s_waitcnt vmcnt(10)
  v_mfma_f32_32x32x16_bf16 v[8:23], v[144:147], v[152:155], v[8:23]
  v_mfma_f32_32x32x16_bf16 v[24:39], v[148:151], v[152:155], v[24:39]
  v_mfma_f32_32x32x16_bf16 v[40:55], v[144:147], v[156:159], v[40:55]
  v_mfma_f32_32x32x16_bf16 v[56:71], v[148:151], v[156:159], v[56:71]
  v_mfma_f32_32x32x16_bf16 v[72:87], v[144:147], v[160:163], v[72:87]
  v_mfma_f32_32x32x16_bf16 v[88:103], v[148:151], v[160:163], v[88:103]
  s_waitcnt vmcnt(5)
  v_mfma_f32_32x32x16_bf16 v[8:23], v[104:107], v[112:115], v[8:23]
  v_mfma_f32_32x32x16_bf16 v[24:39], v[108:111], v[112:115], v[24:39]
  v_mfma_f32_32x32x16_bf16 v[40:55], v[104:107], v[116:119], v[40:55]
  v_mfma_f32_32x32x16_bf16 v[56:71], v[108:111], v[116:119], v[56:71]
  v_mfma_f32_32x32x16_bf16 v[72:87], v[104:107], v[120:123], v[72:87]
  v_mfma_f32_32x32x16_bf16 v[88:103], v[108:111], v[120:123], v[88:103]
  s_waitcnt vmcnt(0)
  v_mfma_f32_32x32x16_bf16 v[8:23], v[124:127], v[132:135], v[8:23]
  v_mfma_f32_32x32x16_bf16 v[24:39], v[128:131], v[132:135], v[24:39]
  v_mfma_f32_32x32x16_bf16 v[40:55], v[124:127], v[136:139], v[40:55]
  v_mfma_f32_32x32x16_bf16 v[56:71], v[128:131], v[136:139], v[56:71]
  v_mfma_f32_32x32x16_bf16 v[72:87], v[124:127], v[140:143], v[72:87]
  v_mfma_f32_32x32x16_bf16 v[88:103], v[128:131], v[140:143], v[88:103]
  s_setprio 3
  s_mul_i32 s46, s44, 88064
  s_lshl_b32 s47, s45, 11
  s_add_u32 s46, s46, s47
  s_mov_b32 s48, 0xbfb8aa3b
  s_nop 7
  v_mul_f32 v104, s48, v8
  v_mul_f32 v105, s48, v9
  v_mul_f32 v106, s48, v10
  v_mul_f32 v107, s48, v11
  v_mul_f32 v108, s48, v12
  v_mul_f32 v109, s48, v13
  v_mul_f32 v110, s48, v14
  v_mul_f32 v111, s48, v15
  v_mul_f32 v112, s48, v16
  v_mul_f32 v113, s48, v17
  v_mul_f32 v114, s48, v18
  v_mul_f32 v115, s48, v19
  v_mul_f32 v116, s48, v20
  v_mul_f32 v117, s48, v21
  v_mul_f32 v118, s48, v22
  v_mul_f32 v119, s48, v23
  v_exp_f32 v104, v104
  v_exp_f32 v105, v105
  v_exp_f32 v106, v106
  v_exp_f32 v107, v107
  v_exp_f32 v108, v108
  v_exp_f32 v109, v109
  v_exp_f32 v110, v110
  v_exp_f32 v111, v111
  v_exp_f32 v112, v112
  v_exp_f32 v113, v113
  v_exp_f32 v114, v114
  v_exp_f32 v115, v115
  v_exp_f32 v116, v116
  v_exp_f32 v117, v117
  v_exp_f32 v118, v118
  v_exp_f32 v119, v119
  v_mul_f32 v8, v8, v24
  v_mul_f32 v9, v9, v25
  v_mul_f32 v10, v10, v26
  v_mul_f32 v11, v11, v27
  v_mul_f32 v12, v12, v28
  v_mul_f32 v13, v13, v29
  v_mul_f32 v14, v14, v30
  v_mul_f32 v15, v15, v31
  v_mul_f32 v16, v16, v32
  v_mul_f32 v17, v17, v33
  v_mul_f32 v18, v18, v34
  v_mul_f32 v19, v19, v35
  v_mul_f32 v20, v20, v36
  v_mul_f32 v21, v21, v37
  v_mul_f32 v22, v22, v38
  v_mul_f32 v23, v23, v39
  v_add_f32 v104, 1.0, v104
  v_add_f32 v105, 1.0, v105
  v_add_f32 v106, 1.0, v106
  v_add_f32 v107, 1.0, v107
  v_add_f32 v108, 1.0, v108
  v_add_f32 v109, 1.0, v109
  v_add_f32 v110, 1.0, v110
  v_add_f32 v111, 1.0, v111
  v_add_f32 v112, 1.0, v112
  v_add_f32 v113, 1.0, v113
  v_add_f32 v114, 1.0, v114
  v_add_f32 v115, 1.0, v115
  v_add_f32 v116, 1.0, v116
  v_add_f32 v117, 1.0, v117
  v_add_f32 v118, 1.0, v118
  v_add_f32 v119, 1.0, v119
  v_rcp_f32 v104, v104
  v_rcp_f32 v105, v105
  v_rcp_f32 v106, v106
  v_rcp_f32 v107, v107
  v_rcp_f32 v108, v108
  v_rcp_f32 v109, v109
  v_rcp_f32 v110, v110
  v_rcp_f32 v111, v111
  v_rcp_f32 v112, v112
  v_rcp_f32 v113, v113
  v_rcp_f32 v114, v114
  v_rcp_f32 v115, v115
  v_rcp_f32 v116, v116
  v_rcp_f32 v117, v117
  v_rcp_f32 v118, v118
  v_rcp_f32 v119, v119
  s_nop 0
  v_mul_f32 v8, v8, v104
  v_mul_f32 v9, v9, v105
  v_mul_f32 v10, v10, v106
  v_mul_f32 v11, v11, v107
  v_mul_f32 v12, v12, v108
  v_mul_f32 v13, v13, v109
  v_mul_f32 v14, v14, v110
  v_mul_f32 v15, v15, v111
  v_mul_f32 v16, v16, v112
  v_mul_f32 v17, v17, v113
  v_mul_f32 v18, v18, v114
  v_mul_f32 v19, v19, v115
  v_mul_f32 v20, v20, v116
  v_mul_f32 v21, v21, v117
  v_mul_f32 v22, v22, v118
  v_mul_f32 v23, v23, v119
  v_cvt_pk_bf16_f32 v8, v8, v9
  v_cvt_pk_bf16_f32 v9, v10, v11
  v_cvt_pk_bf16_f32 v10, v12, v13
  v_cvt_pk_bf16_f32 v11, v14, v15
  v_cvt_pk_bf16_f32 v12, v16, v17
  v_cvt_pk_bf16_f32 v13, v18, v19
  v_cvt_pk_bf16_f32 v14, v20, v21
  v_cvt_pk_bf16_f32 v15, v22, v23
  buffer_store_dwordx4 v[8:11], v3, s[32:35], s46 offen sc0 sc1
  buffer_store_dwordx4 v[12:15], v3, s[32:35], s46 offen offset:1024 sc0 sc1
  s_add_u32 s46, s46, 88064
  v_mul_f32 v104, s48, v40
  v_mul_f32 v105, s48, v41
  v_mul_f32 v106, s48, v42
  v_mul_f32 v107, s48, v43
  v_mul_f32 v108, s48, v44
  v_mul_f32 v109, s48, v45
  v_mul_f32 v110, s48, v46
  v_mul_f32 v111, s48, v47
  v_mul_f32 v112, s48, v48
  v_mul_f32 v113, s48, v49
  v_mul_f32 v114, s48, v50
  v_mul_f32 v115, s48, v51
  v_mul_f32 v116, s48, v52
  v_mul_f32 v117, s48, v53
  v_mul_f32 v118, s48, v54
  v_mul_f32 v119, s48, v55
  v_exp_f32 v104, v104
  v_exp_f32 v105, v105
  v_exp_f32 v106, v106
  v_exp_f32 v107, v107
  v_exp_f32 v108, v108
  v_exp_f32 v109, v109
  v_exp_f32 v110, v110
  v_exp_f32 v111, v111
  v_exp_f32 v112, v112
  v_exp_f32 v113, v113
  v_exp_f32 v114, v114
  v_exp_f32 v115, v115
  v_exp_f32 v116, v116
  v_exp_f32 v117, v117
  v_exp_f32 v118, v118
  v_exp_f32 v119, v119
  v_mul_f32 v40, v40, v56
  v_mul_f32 v41, v41, v57
  v_mul_f32 v42, v42, v58
  v_mul_f32 v43, v43, v59
  v_mul_f32 v44, v44, v60
  v_mul_f32 v45, v45, v61
  v_mul_f32 v46, v46, v62
  v_mul_f32 v47, v47, v63
  v_mul_f32 v48, v48, v64
  v_mul_f32 v49, v49, v65
  v_mul_f32 v50, v50, v66
  v_mul_f32 v51, v51, v67
  v_mul_f32 v52, v52, v68
  v_mul_f32 v53, v53, v69
  v_mul_f32 v54, v54, v70
  v_mul_f32 v55, v55, v71
  v_add_f32 v104, 1.0, v104
  v_add_f32 v105, 1.0, v105
  v_add_f32 v106, 1.0, v106
  v_add_f32 v107, 1.0, v107
  v_add_f32 v108, 1.0, v108
  v_add_f32 v109, 1.0, v109
  v_add_f32 v110, 1.0, v110
  v_add_f32 v111, 1.0, v111
  v_add_f32 v112, 1.0, v112
  v_add_f32 v113, 1.0, v113
  v_add_f32 v114, 1.0, v114
  v_add_f32 v115, 1.0, v115
  v_add_f32 v116, 1.0, v116
  v_add_f32 v117, 1.0, v117
  v_add_f32 v118, 1.0, v118
  v_add_f32 v119, 1.0, v119
  v_rcp_f32 v104, v104
  v_rcp_f32 v105, v105
  v_rcp_f32 v106, v106
  v_rcp_f32 v107, v107
  v_rcp_f32 v108, v108
  v_rcp_f32 v109, v109
  v_rcp_f32 v110, v110
  v_rcp_f32 v111, v111
  v_rcp_f32 v112, v112
  v_rcp_f32 v113, v113
  v_rcp_f32 v114, v114
  v_rcp_f32 v115, v115
  v_rcp_f32 v116, v116
  v_rcp_f32 v117, v117
  v_rcp_f32 v118, v118
  v_rcp_f32 v119, v119
  s_nop 0
  v_mul_f32 v40, v40, v104
  v_mul_f32 v41, v41, v105
  v_mul_f32 v42, v42, v106
  v_mul_f32 v43, v43, v107
  v_mul_f32 v44, v44, v108
  v_mul_f32 v45, v45, v109
  v_mul_f32 v46, v46, v110
  v_mul_f32 v47, v47, v111
  v_mul_f32 v48, v48, v112
  v_mul_f32 v49, v49, v113
  v_mul_f32 v50, v50, v114
  v_mul_f32 v51, v51, v115
  v_mul_f32 v52, v52, v116
  v_mul_f32 v53, v53, v117
  v_mul_f32 v54, v54, v118
  v_mul_f32 v55, v55, v119
  v_cvt_pk_bf16_f32 v40, v40, v41
  v_cvt_pk_bf16_f32 v41, v42, v43
  v_cvt_pk_bf16_f32 v42, v44, v45
  v_cvt_pk_bf16_f32 v43, v46, v47
  v_cvt_pk_bf16_f32 v44, v48, v49
  v_cvt_pk_bf16_f32 v45, v50, v51
  v_cvt_pk_bf16_f32 v46, v52, v53
  v_cvt_pk_bf16_f32 v47, v54, v55
  buffer_store_dwordx4 v[40:43], v3, s[32:35], s46 offen sc0 sc1
  buffer_store_dwordx4 v[44:47], v3, s[32:35], s46 offen offset:1024 sc0 sc1
  s_add_u32 s46, s46, 88064
  v_mul_f32 v104, s48, v72
  v_mul_f32 v105, s48, v73
  v_mul_f32 v106, s48, v74
  v_mul_f32 v107, s48, v75
  v_mul_f32 v108, s48, v76
  v_mul_f32 v109, s48, v77
  v_mul_f32 v110, s48, v78
  v_mul_f32 v111, s48, v79
  v_mul_f32 v112, s48, v80
  v_mul_f32 v113, s48, v81
  v_mul_f32 v114, s48, v82
  v_mul_f32 v115, s48, v83
  v_mul_f32 v116, s48, v84
  v_mul_f32 v117, s48, v85
  v_mul_f32 v118, s48, v86
  v_mul_f32 v119, s48, v87
  v_exp_f32 v104, v104
  v_exp_f32 v105, v105
  v_exp_f32 v106, v106
  v_exp_f32 v107, v107
  v_exp_f32 v108, v108
  v_exp_f32 v109, v109
  v_exp_f32 v110, v110
  v_exp_f32 v111, v111
  v_exp_f32 v112, v112
  v_exp_f32 v113, v113
  v_exp_f32 v114, v114
  v_exp_f32 v115, v115
  v_exp_f32 v116, v116
  v_exp_f32 v117, v117
  v_exp_f32 v118, v118
  v_exp_f32 v119, v119
  v_mul_f32 v72, v72, v88
  v_mul_f32 v73, v73, v89
  v_mul_f32 v74, v74, v90
  v_mul_f32 v75, v75, v91
  v_mul_f32 v76, v76, v92
  v_mul_f32 v77, v77, v93
  v_mul_f32 v78, v78, v94
  v_mul_f32 v79, v79, v95
  v_mul_f32 v80, v80, v96
  v_mul_f32 v81, v81, v97
  v_mul_f32 v82, v82, v98
  v_mul_f32 v83, v83, v99
  v_mul_f32 v84, v84, v100
  v_mul_f32 v85, v85, v101
  v_mul_f32 v86, v86, v102
  v_mul_f32 v87, v87, v103
  v_add_f32 v104, 1.0, v104
  v_add_f32 v105, 1.0, v105
  v_add_f32 v106, 1.0, v106
  v_add_f32 v107, 1.0, v107
  v_add_f32 v108, 1.0, v108
  v_add_f32 v109, 1.0, v109
  v_add_f32 v110, 1.0, v110
  v_add_f32 v111, 1.0, v111
  v_add_f32 v112, 1.0, v112
  v_add_f32 v113, 1.0, v113
  v_add_f32 v114, 1.0, v114
  v_add_f32 v115, 1.0, v115
  v_add_f32 v116, 1.0, v116
  v_add_f32 v117, 1.0, v117
  v_add_f32 v118, 1.0, v118
  v_add_f32 v119, 1.0, v119
  v_rcp_f32 v104, v104
  v_rcp_f32 v105, v105
  v_rcp_f32 v106, v106
  v_rcp_f32 v107, v107
  v_rcp_f32 v108, v108
  v_rcp_f32 v109, v109
  v_rcp_f32 v110, v110
  v_rcp_f32 v111, v111
  v_rcp_f32 v112, v112
  v_rcp_f32 v113, v113
  v_rcp_f32 v114, v114
  v_rcp_f32 v115, v115
  v_rcp_f32 v116, v116
  v_rcp_f32 v117, v117
  v_rcp_f32 v118, v118
  v_rcp_f32 v119, v119
  s_nop 0
  v_mul_f32 v72, v72, v104
  v_mul_f32 v73, v73, v105
  v_mul_f32 v74, v74, v106
  v_mul_f32 v75, v75, v107
  v_mul_f32 v76, v76, v108
  v_mul_f32 v77, v77, v109
  v_mul_f32 v78, v78, v110
  v_mul_f32 v79, v79, v111
  v_mul_f32 v80, v80, v112
  v_mul_f32 v81, v81, v113
  v_mul_f32 v82, v82, v114
  v_mul_f32 v83, v83, v115
  v_mul_f32 v84, v84, v116
  v_mul_f32 v85, v85, v117
  v_mul_f32 v86, v86, v118
  v_mul_f32 v87, v87, v119
  v_cvt_pk_bf16_f32 v72, v72, v73
  v_cvt_pk_bf16_f32 v73, v74, v75
  v_cvt_pk_bf16_f32 v74, v76, v77
  v_cvt_pk_bf16_f32 v75, v78, v79
  v_cvt_pk_bf16_f32 v76, v80, v81
  v_cvt_pk_bf16_f32 v77, v82, v83
  v_cvt_pk_bf16_f32 v78, v84, v85
  v_cvt_pk_bf16_f32 v79, v86, v87
  buffer_store_dwordx4 v[72:75], v3, s[32:35], s46 offen sc0 sc1
  buffer_store_dwordx4 v[76:79], v3, s[32:35], s46 offen offset:1024 sc0 sc1
  s_add_u32 s46, s46, 88064
  s_mov_b32 s64, s20
  s_mov_b32 s65, s21
  s_mov_b32 s66, 0x1a00000
  s_mov_b32 s67, 0x20000
  v_mov_b32 v73, 1
  v_mov_b32 v74, 0
  s_mov_b64 exec, 1
  s_waitcnt vmcnt(0)
  buffer_store_dword v73, v74, s[64:67], s62 offen sc0 sc1
  s_mov_b64 exec, -1
  s_branch k2_kernel_join
k2_kernel_idle:
  s_barrier
  s_mov_b32 s64, s20
  s_mov_b32 s65, s21
  s_mov_b32 s66, 0x1a00000
  s_mov_b32 s67, 0x20000
k2_kernel_join:
  s_load_dwordx2 s[4:5], s[0:1], 0
  s_load_dwordx2 s[6:7], s[0:1], 56
  v_mov_b32 v72, 0x20000
  v_mov_b32 v73, 1
  s_lshl_b32 s43, s40, 2
  s_lshr_b32 s44, s41, 3
  s_add_u32 s43, s43, s44
  s_and_b32 s44, s41, 7
  s_mul_i32 s46, s42, 22
  s_cmp_eq_u32 s42, 3
  s_cselect_b32 s46, 65, s46
  s_lshl_b32 s46, s46, 10
  s_mul_i32 s45, s43, 176128
  s_add_u32 s45, s45, s46
  s_add_u32 s45, s45, 16777216
  s_mul_i32 s47, s44, 176128
  s_add_u32 s47, s47, s46
  s_add_u32 s47, s47, 13631488
  v_add_u32 v4, s45, v3
  v_add_u32 v5, 88064, v4
  v_add_u32 v6, s47, v3
  v_add_u32 v7, 88064, v6
  s_cmp_ge_u32 s42, 2
  s_cselect_b32 s49, 0x40000000, 20480
  s_mul_i32 s56, s43, 43
  s_lshr_b32 s56, s56, 6
  s_mul_i32 s57, s43, 43
  s_add_u32 s57, s57, 21
  s_lshr_b32 s57, s57, 6
  s_lshl_b32 s56, s56, 8
  s_lshl_b32 s57, s57, 8
  s_add_u32 s56, s56, 25165824
  s_add_u32 s57, s57, 25165824
  v_min_u32 v75, 42, v1
  v_lshlrev_b32 v75, 2, v75
  s_waitcnt lgkmcnt(0)
  v_mov_b32 v8, 0
  v_mov_b32 v9, 0
  v_mov_b32 v10, 0
  v_mov_b32 v11, 0
  v_mov_b32 v12, 0
  v_mov_b32 v13, 0
  v_mov_b32 v14, 0
  v_mov_b32 v15, 0
  v_mov_b32 v16, 0
  v_mov_b32 v17, 0
  v_mov_b32 v18, 0
  v_mov_b32 v19, 0
  v_mov_b32 v20, 0
  v_mov_b32 v21, 0
  v_mov_b32 v22, 0
  v_mov_b32 v23, 0
  v_mov_b32 v24, 0
  v_mov_b32 v25, 0
  v_mov_b32 v26, 0
  v_mov_b32 v27, 0
  v_mov_b32 v28, 0
  v_mov_b32 v29, 0
  v_mov_b32 v30, 0
  v_mov_b32 v31, 0
  v_mov_b32 v32, 0
  v_mov_b32 v33, 0
  v_mov_b32 v34, 0
  v_mov_b32 v35, 0
  v_mov_b32 v36, 0
  v_mov_b32 v37, 0
  v_mov_b32 v38, 0
  v_mov_b32 v39, 0
  v_mov_b32 v40, 0
  v_mov_b32 v41, 0
  v_mov_b32 v42, 0
  v_mov_b32 v43, 0
  v_mov_b32 v44, 0
  v_mov_b32 v45, 0
  v_mov_b32 v46, 0
  v_mov_b32 v47, 0
  v_mov_b32 v48, 0
  v_mov_b32 v49, 0
  v_mov_b32 v50, 0
  v_mov_b32 v51, 0
  v_mov_b32 v52, 0
  v_mov_b32 v53, 0
  v_mov_b32 v54, 0
  v_mov_b32 v55, 0
  v_mov_b32 v56, 0
  v_mov_b32 v57, 0
  v_mov_b32 v58, 0
  v_mov_b32 v59, 0
  v_mov_b32 v60, 0
  v_mov_b32 v61, 0
  v_mov_b32 v62, 0
  v_mov_b32 v63, 0
  v_mov_b32 v64, 0
  v_mov_b32 v65, 0
  v_mov_b32 v66, 0
  v_mov_b32 v67, 0
  v_mov_b32 v68, 0
  v_mov_b32 v69, 0
  v_mov_b32 v70, 0
  v_mov_b32 v71, 0
  s_cmp_eq_u32 s42, 0
  s_cbranch_scc0 k2_kernel_lw
  s_mov_b32 s55, 0
k2_kernel_pa:
  buffer_load_dword v76, v75, s[64:67], s56 offen sc0 sc1
  buffer_load_dword v77, v75, s[64:67], s57 offen sc0 sc1
  s_add_u32 s55, s55, 1
  s_waitcnt vmcnt(0)
  v_and_b32 v76, v76, v77
  v_cmp_eq_u32 vcc, 0, v76
  s_cmp_ge_u32 s55, 0x8000
  s_cbranch_scc1 k2_kernel_pax
  s_cmp_eq_u64 vcc, 0
  s_cbranch_scc0 k2_kernel_pa
k2_kernel_pax:
  ds_write_b32 v72, v73 offset:12
k2_kernel_lw:
  s_nop 15
  s_nop 15
  s_nop 15
  s_nop 15
  ds_read_b32 v76, v72 offset:12
  s_waitcnt lgkmcnt(0)
  v_readfirstlane_b32 s47, v76
  s_cmp_eq_u32 s47, 0
  s_cbranch_scc1 k2_kernel_lw
  s_setprio 0
  s_mov_b32 s48, 0
  buffer_load_dwordx4 v[72:75], v6, s[64:67], s48 offen offset:0
  buffer_load_dwordx4 v[80:83], v4, s[64:67], s48 offen offset:0
  buffer_load_dwordx4 v[76:79], v7, s[64:67], s48 offen offset:0
  buffer_load_dwordx4 v[84:87], v5, s[64:67], s48 offen offset:0
  buffer_load_dwordx4 v[88:91], v6, s[64:67], s48 offen offset:1024
  buffer_load_dwordx4 v[96:99], v4, s[64:67], s48 offen offset:1024
  buffer_load_dwordx4 v[92:95], v7, s[64:67], s48 offen offset:1024
  buffer_load_dwordx4 v[100:103], v5, s[64:67], s48 offen offset:1024
  buffer_load_dwordx4 v[104:107], v6, s[64:67], s48 offen offset:2048
  buffer_load_dwordx4 v[112:115], v4, s[64:67], s48 offen offset:2048
  buffer_load_dwordx4 v[108:111], v7, s[64:67], s48 offen offset:2048
  buffer_load_dwordx4 v[116:119], v5, s[64:67], s48 offen offset:2048
  buffer_load_dwordx4 v[120:123], v6, s[64:67], s48 offen offset:3072
  buffer_load_dwordx4 v[128:131], v4, s[64:67], s48 offen offset:3072
  buffer_load_dwordx4 v[124:127], v7, s[64:67], s48 offen offset:3072
  buffer_load_dwordx4 v[132:135], v5, s[64:67], s48 offen offset:3072
  s_mov_b32 s48, 4096
  buffer_load_dwordx4 v[136:139], v6, s[64:67], s48 offen offset:0
  buffer_load_dwordx4 v[144:147], v4, s[64:67], s48 offen offset:0
  buffer_load_dwordx4 v[140:143], v7, s[64:67], s48 offen offset:0
  buffer_load_dwordx4 v[148:151], v5, s[64:67], s48 offen offset:0
  buffer_load_dwordx4 v[152:155], v6, s[64:67], s48 offen offset:1024
  buffer_load_dwordx4 v[160:163], v4, s[64:67], s48 offen offset:1024
  buffer_load_dwordx4 v[156:159], v7, s[64:67], s48 offen offset:1024
  buffer_load_dwordx4 v[164:167], v5, s[64:67], s48 offen offset:1024
  s_mov_b32 s28, s4
  s_mov_b32 s29, s5
  s_mov_b32 s30, 0x200000
  s_mov_b32 s31, 0x20000
  s_mov_b32 s32, s6
  s_mov_b32 s33, s7
  s_mov_b32 s34, 0x200000
  s_mov_b32 s35, 0x20000
  v_and_b32 v2, 31, v1
  v_lshlrev_b32 v2, 10, v2
  v_lshrrev_b32 v0, 5, v1
  v_lshl_add_u32 v2, v0, 4, v2
  s_lshl_b32 s50, s43, 16
  s_and_b32 s51, s42, 1
  s_lshl_b32 s51, s51, 15
  s_add_u32 s50, s50, s51
  s_lshl_b32 s52, s44, 7
  s_add_u32 s50, s50, s52
  s_lshr_b32 s52, s42, 1
  s_lshl_b32 s53, s52, 6
  s_add_u32 s50, s50, s53
  s_lshl_b32 s52, s52, 15
  s_waitcnt vmcnt(20)
  v_mfma_f32_32x32x16_bf16 v[8:23], v[72:75], v[80:83], v[8:23]
  v_mfma_f32_32x32x16_bf16 v[24:39], v[72:75], v[84:87], v[24:39]
  v_mfma_f32_32x32x16_bf16 v[40:55], v[76:79], v[80:83], v[40:55]
  v_mfma_f32_32x32x16_bf16 v[56:71], v[76:79], v[84:87], v[56:71]
  buffer_load_dwordx4 v[72:75], v6, s[64:67], s48 offen offset:2048
  buffer_load_dwordx4 v[80:83], v4, s[64:67], s48 offen offset:2048
  buffer_load_dwordx4 v[76:79], v7, s[64:67], s48 offen offset:2048
  buffer_load_dwordx4 v[84:87], v5, s[64:67], s48 offen offset:2048
  s_waitcnt vmcnt(20)
  v_mfma_f32_32x32x16_bf16 v[8:23], v[88:91], v[96:99], v[8:23]
  v_mfma_f32_32x32x16_bf16 v[24:39], v[88:91], v[100:103], v[24:39]
  v_mfma_f32_32x32x16_bf16 v[40:55], v[92:95], v[96:99], v[40:55]
  v_mfma_f32_32x32x16_bf16 v[56:71], v[92:95], v[100:103], v[56:71]
  buffer_load_dwordx4 v[88:91], v6, s[64:67], s48 offen offset:3072
  buffer_load_dwordx4 v[96:99], v4, s[64:67], s48 offen offset:3072
  buffer_load_dwordx4 v[92:95], v7, s[64:67], s48 offen offset:3072
  buffer_load_dwordx4 v[100:103], v5, s[64:67], s48 offen offset:3072
  s_waitcnt vmcnt(20)
  v_mfma_f32_32x32x16_bf16 v[8:23], v[104:107], v[112:115], v[8:23]
  v_mfma_f32_32x32x16_bf16 v[24:39], v[104:107], v[116:119], v[24:39]
  v_mfma_f32_32x32x16_bf16 v[40:55], v[108:111], v[112:115], v[40:55]
  v_mfma_f32_32x32x16_bf16 v[56:71], v[108:111], v[116:119], v[56:71]
  s_mov_b32 s48, 8192
  buffer_load_dwordx4 v[104:107], v6, s[64:67], s48 offen offset:0
  buffer_load_dwordx4 v[112:115], v4, s[64:67], s48 offen offset:0
  buffer_load_dwordx4 v[108:111], v7, s[64:67], s48 offen offset:0
  buffer_load_dwordx4 v[116:119], v5, s[64:67], s48 offen offset:0
  s_waitcnt vmcnt(20)
  v_mfma_f32_32x32x16_bf16 v[8:23], v[120:123], v[128:131], v[8:23]
  v_mfma_f32_32x32x16_bf16 v[24:39], v[120:123], v[132:135], v[24:39]
  v_mfma_f32_32x32x16_bf16 v[40:55], v[124:127], v[128:131], v[40:55]
  v_mfma_f32_32x32x16_bf16 v[56:71], v[124:127], v[132:135], v[56:71]
  buffer_load_dwordx4 v[120:123], v6, s[64:67], s48 offen offset:1024
  buffer_load_dwordx4 v[128:131], v4, s[64:67], s48 offen offset:1024
  buffer_load_dwordx4 v[124:127], v7, s[64:67], s48 offen offset:1024
  buffer_load_dwordx4 v[132:135], v5, s[64:67], s48 offen offset:1024
  s_waitcnt vmcnt(20)
  v_mfma_f32_32x32x16_bf16 v[8:23], v[136:139], v[144:147], v[8:23]
  v_mfma_f32_32x32x16_bf16 v[24:39], v[136:139], v[148:151], v[24:39]
  v_mfma_f32_32x32x16_bf16 v[40:55], v[140:143], v[144:147], v[40:55]
  v_mfma_f32_32x32x16_bf16 v[56:71], v[140:143], v[148:151], v[56:71]
  buffer_load_dwordx4 v[136:139], v6, s[64:67], s48 offen offset:2048
  buffer_load_dwordx4 v[144:147], v4, s[64:67], s48 offen offset:2048
  buffer_load_dwordx4 v[140:143], v7, s[64:67], s48 offen offset:2048
  buffer_load_dwordx4 v[148:151], v5, s[64:67], s48 offen offset:2048
  s_waitcnt vmcnt(20)
  v_mfma_f32_32x32x16_bf16 v[8:23], v[152:155], v[160:163], v[8:23]
  v_mfma_f32_32x32x16_bf16 v[24:39], v[152:155], v[164:167], v[24:39]
  v_mfma_f32_32x32x16_bf16 v[40:55], v[156:159], v[160:163], v[40:55]
  v_mfma_f32_32x32x16_bf16 v[56:71], v[156:159], v[164:167], v[56:71]
  buffer_load_dwordx4 v[152:155], v6, s[64:67], s48 offen offset:3072
  buffer_load_dwordx4 v[160:163], v4, s[64:67], s48 offen offset:3072
  buffer_load_dwordx4 v[156:159], v7, s[64:67], s48 offen offset:3072
  buffer_load_dwordx4 v[164:167], v5, s[64:67], s48 offen offset:3072
  s_waitcnt vmcnt(20)
  v_mfma_f32_32x32x16_bf16 v[8:23], v[72:75], v[80:83], v[8:23]
  v_mfma_f32_32x32x16_bf16 v[24:39], v[72:75], v[84:87], v[24:39]
  v_mfma_f32_32x32x16_bf16 v[40:55], v[76:79], v[80:83], v[40:55]
  v_mfma_f32_32x32x16_bf16 v[56:71], v[76:79], v[84:87], v[56:71]
  s_mov_b32 s48, 12288
  buffer_load_dwordx4 v[72:75], v6, s[64:67], s48 offen offset:0
  buffer_load_dwordx4 v[80:83], v4, s[64:67], s48 offen offset:0
  buffer_load_dwordx4 v[76:79], v7, s[64:67], s48 offen offset:0
  buffer_load_dwordx4 v[84:87], v5, s[64:67], s48 offen offset:0
  s_waitcnt vmcnt(20)
  v_mfma_f32_32x32x16_bf16 v[8:23], v[88:91], v[96:99], v[8:23]
  v_mfma_f32_32x32x16_bf16 v[24:39], v[88:91], v[100:103], v[24:39]
  v_mfma_f32_32x32x16_bf16 v[40:55], v[92:95], v[96:99], v[40:55]
  v_mfma_f32_32x32x16_bf16 v[56:71], v[92:95], v[100:103], v[56:71]
  buffer_load_dwordx4 v[88:91], v6, s[64:67], s48 offen offset:1024
  buffer_load_dwordx4 v[96:99], v4, s[64:67], s48 offen offset:1024
  buffer_load_dwordx4 v[92:95], v7, s[64:67], s48 offen offset:1024
  buffer_load_dwordx4 v[100:103], v5, s[64:67], s48 offen offset:1024
  s_waitcnt vmcnt(20)
  v_mfma_f32_32x32x16_bf16 v[8:23], v[104:107], v[112:115], v[8:23]
  v_mfma_f32_32x32x16_bf16 v[24:39], v[104:107], v[116:119], v[24:39]
  v_mfma_f32_32x32x16_bf16 v[40:55], v[108:111], v[112:115], v[40:55]
  v_mfma_f32_32x32x16_bf16 v[56:71], v[108:111], v[116:119], v[56:71]
  buffer_load_dwordx4 v[104:107], v6, s[64:67], s48 offen offset:2048
  buffer_load_dwordx4 v[112:115], v4, s[64:67], s48 offen offset:2048
  buffer_load_dwordx4 v[108:111], v7, s[64:67], s48 offen offset:2048
  buffer_load_dwordx4 v[116:119], v5, s[64:67], s48 offen offset:2048
  s_waitcnt vmcnt(20)
  v_mfma_f32_32x32x16_bf16 v[8:23], v[120:123], v[128:131], v[8:23]
  v_mfma_f32_32x32x16_bf16 v[24:39], v[120:123], v[132:135], v[24:39]
  v_mfma_f32_32x32x16_bf16 v[40:55], v[124:127], v[128:131], v[40:55]
  v_mfma_f32_32x32x16_bf16 v[56:71], v[124:127], v[132:135], v[56:71]
  buffer_load_dwordx4 v[120:123], v6, s[64:67], s48 offen offset:3072
  buffer_load_dwordx4 v[128:131], v4, s[64:67], s48 offen offset:3072
  buffer_load_dwordx4 v[124:127], v7, s[64:67], s48 offen offset:3072
  buffer_load_dwordx4 v[132:135], v5, s[64:67], s48 offen offset:3072
  s_waitcnt vmcnt(20)
  v_mfma_f32_32x32x16_bf16 v[8:23], v[136:139], v[144:147], v[8:23]
  v_mfma_f32_32x32x16_bf16 v[24:39], v[136:139], v[148:151], v[24:39]
  v_mfma_f32_32x32x16_bf16 v[40:55], v[140:143], v[144:147], v[40:55]
  v_mfma_f32_32x32x16_bf16 v[56:71], v[140:143], v[148:151], v[56:71]
  s_mov_b32 s48, 16384
  buffer_load_dwordx4 v[136:139], v6, s[64:67], s48 offen offset:0
  buffer_load_dwordx4 v[144:147], v4, s[64:67], s48 offen offset:0
  buffer_load_dwordx4 v[140:143], v7, s[64:67], s48 offen offset:0
  buffer_load_dwordx4 v[148:151], v5, s[64:67], s48 offen offset:0
  s_waitcnt vmcnt(20)
  v_mfma_f32_32x32x16_bf16 v[8:23], v[152:155], v[160:163], v[8:23]
  v_mfma_f32_32x32x16_bf16 v[24:39], v[152:155], v[164:167], v[24:39]
  v_mfma_f32_32x32x16_bf16 v[40:55], v[156:159], v[160:163], v[40:55]
  v_mfma_f32_32x32x16_bf16 v[56:71], v[156:159], v[164:167], v[56:71]
  buffer_load_dwordx4 v[152:155], v6, s[64:67], s48 offen offset:1024
  buffer_load_dwordx4 v[160:163], v4, s[64:67], s48 offen offset:1024
  buffer_load_dwordx4 v[156:159], v7, s[64:67], s48 offen offset:1024
  buffer_load_dwordx4 v[164:167], v5, s[64:67], s48 offen offset:1024
  s_waitcnt vmcnt(20)
  v_mfma_f32_32x32x16_bf16 v[8:23], v[72:75], v[80:83], v[8:23]
  v_mfma_f32_32x32x16_bf16 v[24:39], v[72:75], v[84:87], v[24:39]
  v_mfma_f32_32x32x16_bf16 v[40:55], v[76:79], v[80:83], v[40:55]
  v_mfma_f32_32x32x16_bf16 v[56:71], v[76:79], v[84:87], v[56:71]
  buffer_load_dwordx4 v[72:75], v6, s[64:67], s48 offen offset:2048
  buffer_load_dwordx4 v[80:83], v4, s[64:67], s48 offen offset:2048
  buffer_load_dwordx4 v[76:79], v7, s[64:67], s48 offen offset:2048
  buffer_load_dwordx4 v[84:87], v5, s[64:67], s48 offen offset:2048
  s_waitcnt vmcnt(20)
  v_mfma_f32_32x32x16_bf16 v[8:23], v[88:91], v[96:99], v[8:23]
  v_mfma_f32_32x32x16_bf16 v[24:39], v[88:91], v[100:103], v[24:39]
  v_mfma_f32_32x32x16_bf16 v[40:55], v[92:95], v[96:99], v[40:55]
  v_mfma_f32_32x32x16_bf16 v[56:71], v[92:95], v[100:103], v[56:71]
  buffer_load_dwordx4 v[88:91], v6, s[64:67], s48 offen offset:3072
  buffer_load_dwordx4 v[96:99], v4, s[64:67], s48 offen offset:3072
  buffer_load_dwordx4 v[92:95], v7, s[64:67], s48 offen offset:3072
  buffer_load_dwordx4 v[100:103], v5, s[64:67], s48 offen offset:3072
  s_waitcnt vmcnt(20)
  v_mfma_f32_32x32x16_bf16 v[8:23], v[104:107], v[112:115], v[8:23]
  v_mfma_f32_32x32x16_bf16 v[24:39], v[104:107], v[116:119], v[24:39]
  v_mfma_f32_32x32x16_bf16 v[40:55], v[108:111], v[112:115], v[40:55]
  v_mfma_f32_32x32x16_bf16 v[56:71], v[108:111], v[116:119], v[56:71]
  s_mov_b32 s48, 20480
  buffer_load_dwordx4 v[104:107], v6, s[64:67], s48 offen offset:0
  buffer_load_dwordx4 v[112:115], v4, s[64:67], s48 offen offset:0
  buffer_load_dwordx4 v[108:111], v7, s[64:67], s48 offen offset:0
  buffer_load_dwordx4 v[116:119], v5, s[64:67], s48 offen offset:0
  s_waitcnt vmcnt(20)
  v_mfma_f32_32x32x16_bf16 v[8:23], v[120:123], v[128:131], v[8:23]
  v_mfma_f32_32x32x16_bf16 v[24:39], v[120:123], v[132:135], v[24:39]
  v_mfma_f32_32x32x16_bf16 v[40:55], v[124:127], v[128:131], v[40:55]
  v_mfma_f32_32x32x16_bf16 v[56:71], v[124:127], v[132:135], v[56:71]
  buffer_load_dwordx4 v[120:123], v6, s[64:67], s49 offen offset:1024
  buffer_load_dwordx4 v[128:131], v4, s[64:67], s49 offen offset:1024
  buffer_load_dwordx4 v[124:127], v7, s[64:67], s49 offen offset:1024
  buffer_load_dwordx4 v[132:135], v5, s[64:67], s49 offen offset:1024
  s_waitcnt vmcnt(20)
  v_mfma_f32_32x32x16_bf16 v[8:23], v[136:139], v[144:147], v[8:23]
  v_mfma_f32_32x32x16_bf16 v[24:39], v[136:139], v[148:151], v[24:39]
  v_mfma_f32_32x32x16_bf16 v[40:55], v[140:143], v[144:147], v[40:55]
  v_mfma_f32_32x32x16_bf16 v[56:71], v[140:143], v[148:151], v[56:71]
  s_waitcnt vmcnt(16)
  v_mfma_f32_32x32x16_bf16 v[8:23], v[152:155], v[160:163], v[8:23]
  v_mfma_f32_32x32x16_bf16 v[24:39], v[152:155], v[164:167], v[24:39]
  v_mfma_f32_32x32x16_bf16 v[40:55], v[156:159], v[160:163], v[40:55]
  v_mfma_f32_32x32x16_bf16 v[56:71], v[156:159], v[164:167], v[56:71]
  s_waitcnt vmcnt(12)
  v_mfma_f32_32x32x16_bf16 v[8:23], v[72:75], v[80:83], v[8:23]
  v_mfma_f32_32x32x16_bf16 v[24:39], v[72:75], v[84:87], v[24:39]
  v_mfma_f32_32x32x16_bf16 v[40:55], v[76:79], v[80:83], v[40:55]
  v_mfma_f32_32x32x16_bf16 v[56:71], v[76:79], v[84:87], v[56:71]
  s_waitcnt vmcnt(8)
  v_mfma_f32_32x32x16_bf16 v[8:23], v[88:91], v[96:99], v[8:23]
  v_mfma_f32_32x32x16_bf16 v[24:39], v[88:91], v[100:103], v[24:39]
  v_mfma_f32_32x32x16_bf16 v[40:55], v[92:95], v[96:99], v[40:55]
  v_mfma_f32_32x32x16_bf16 v[56:71], v[92:95], v[100:103], v[56:71]
  s_waitcnt vmcnt(4)
  v_mfma_f32_32x32x16_bf16 v[8:23], v[104:107], v[112:115], v[8:23]
  v_mfma_f32_32x32x16_bf16 v[24:39], v[104:107], v[116:119], v[24:39]
  v_mfma_f32_32x32x16_bf16 v[40:55], v[108:111], v[112:115], v[40:55]
  v_mfma_f32_32x32x16_bf16 v[56:71], v[108:111], v[116:119], v[56:71]
  s_waitcnt vmcnt(0)
  v_mfma_f32_32x32x16_bf16 v[8:23], v[120:123], v[128:131], v[8:23]
  v_mfma_f32_32x32x16_bf16 v[24:39], v[120:123], v[132:135], v[24:39]
  v_mfma_f32_32x32x16_bf16 v[40:55], v[124:127], v[128:131], v[40:55]
  v_mfma_f32_32x32x16_bf16 v[56:71], v[124:127], v[132:135], v[56:71]
  buffer_load_dwordx4 v[152:155], v2, s[28:31], s50 offen
  buffer_load_dwordx4 v[156:159], v2, s[28:31], s50 offen offset:32
  v_mov_b32 v0, 0x20000
  s_lshl_b32 s53, s42, 14
  s_lshl_b32 s54, s44, 16
  s_add_u32 s54, s54, s53
  s_add_u32 s54, s54, 15728640
  s_lshl_b32 s57, s43, 16
  s_add_u32 s57, s57, s53
  s_add_u32 s57, s57, 8388608
  s_lshl_b32 s58, s42, 12
  v_add_u32 v4, s58, v3
  v_add_u32 v5, s53, v3
  s_setprio 3
k2_kernel_aw:
  s_nop 15
  s_nop 15
  ds_read_b32 v6, v0 offset:8
  s_waitcnt lgkmcnt(0)
  v_readfirstlane_b32 s47, v6
  s_cmp_lt_u32 s47, 8
  s_cbranch_scc1 k2_kernel_aw
  s_setprio 3
  ds_write_b128 v4, v[8:11] offset:0
  ds_write_b128 v4, v[12:15] offset:1024
  ds_write_b128 v4, v[16:19] offset:2048
  ds_write_b128 v4, v[20:23] offset:3072
  ds_write_b128 v4, v[24:27] offset:16384
  ds_write_b128 v4, v[28:31] offset:17408
  ds_write_b128 v4, v[32:35] offset:18432
  ds_write_b128 v4, v[36:39] offset:19456
  ds_write_b128 v4, v[40:43] offset:32768
  ds_write_b128 v4, v[44:47] offset:33792
  ds_write_b128 v4, v[48:51] offset:34816
  ds_write_b128 v4, v[52:55] offset:35840
  ds_write_b128 v4, v[56:59] offset:49152
  ds_write_b128 v4, v[60:63] offset:50176
  ds_write_b128 v4, v[64:67] offset:51200
  ds_write_b128 v4, v[68:71] offset:52224
  s_add_u32 m0, s53, 65536
  s_add_u32 s59, s54, 0
  buffer_load_dwordx4 v3, s[64:67], s59 offen offset:0 lds
  buffer_load_dwordx4 v3, s[64:67], s59 offen offset:1024 lds
  buffer_load_dwordx4 v3, s[64:67], s59 offen offset:2048 lds
  buffer_load_dwordx4 v3, s[64:67], s59 offen offset:3072 lds
  s_add_u32 m0, s53, 69632
  s_add_u32 s59, s54, 4096
  buffer_load_dwordx4 v3, s[64:67], s59 offen offset:0 lds
  buffer_load_dwordx4 v3, s[64:67], s59 offen offset:1024 lds
  buffer_load_dwordx4 v3, s[64:67], s59 offen offset:2048 lds
  buffer_load_dwordx4 v3, s[64:67], s59 offen offset:3072 lds
  s_add_u32 m0, s53, 73728
  s_add_u32 s59, s54, 8192
  buffer_load_dwordx4 v3, s[64:67], s59 offen offset:0 lds
  buffer_load_dwordx4 v3, s[64:67], s59 offen offset:1024 lds
  buffer_load_dwordx4 v3, s[64:67], s59 offen offset:2048 lds
  buffer_load_dwordx4 v3, s[64:67], s59 offen offset:3072 lds
  s_add_u32 m0, s53, 77824
  s_add_u32 s59, s54, 12288
  buffer_load_dwordx4 v3, s[64:67], s59 offen offset:0 lds
  buffer_load_dwordx4 v3, s[64:67], s59 offen offset:1024 lds
  buffer_load_dwordx4 v3, s[64:67], s59 offen offset:2048 lds
  buffer_load_dwordx4 v3, s[64:67], s59 offen offset:3072 lds
  s_waitcnt lgkmcnt(0)
  s_barrier
  ds_read_b128 v[72:75], v5 offset:0
  ds_read_b128 v[88:91], v5 offset:4096
  ds_read_b128 v[104:107], v5 offset:8192
  ds_read_b128 v[120:123], v5 offset:12288
  ds_read_b128 v[76:79], v5 offset:1024
  ds_read_b128 v[92:95], v5 offset:5120
  ds_read_b128 v[108:111], v5 offset:9216
  ds_read_b128 v[124:127], v5 offset:13312
  ds_read_b128 v[80:83], v5 offset:2048
  ds_read_b128 v[96:99], v5 offset:6144
  ds_read_b128 v[112:115], v5 offset:10240
  ds_read_b128 v[128:131], v5 offset:14336
  ds_read_b128 v[84:87], v5 offset:3072
  ds_read_b128 v[100:103], v5 offset:7168
  ds_read_b128 v[116:119], v5 offset:11264
  ds_read_b128 v[132:135], v5 offset:15360
  s_mov_b32 s48, 0xbfb8aa3b
  s_lshr_b32 s56, s43, 2
  s_lshl_b32 s56, s56, 7
  s_add_u32 s56, s56, 25171968
  s_waitcnt lgkmcnt(0)
  s_and_b32 s47, s42, 1
  s_lshl_b32 s47, s47, 6
  s_add_u32 s56, s56, s47
  v_mov_b32 v8, v75
  v_mov_b32 v9, v76
  v_and_b32 v75, 15, v1
  v_lshlrev_b32 v75, 2, v75
  s_mov_b32 s55, 0
k2_kernel_pb:
  buffer_load_dword v76, v75, s[64:67], s56 offen sc0 sc1
  s_add_u32 s55, s55, 1
  s_waitcnt vmcnt(0)
  v_cmp_eq_u32 vcc, 0, v76
  s_cmp_ge_u32 s55, 0x8000
  s_cbranch_scc1 k2_kernel_pbx
  s_cmp_eq_u64 vcc, 0
  s_cbranch_scc0 k2_kernel_pb
k2_kernel_pbx:
  v_mov_b32 v75, v8
  v_mov_b32 v76, v9
k2_kernel_nb:
  s_add_u32 m0, s53, 0
  s_add_u32 s59, s57, 0
  buffer_load_dwordx4 v3, s[64:67], s59 offen offset:0 lds
  buffer_load_dwordx4 v3, s[64:67], s59 offen offset:1024 lds
  buffer_load_dwordx4 v3, s[64:67], s59 offen offset:2048 lds
  buffer_load_dwordx4 v3, s[64:67], s59 offen offset:3072 lds
  s_add_u32 m0, s53, 4096
  s_add_u32 s59, s57, 4096
  buffer_load_dwordx4 v3, s[64:67], s59 offen offset:0 lds
  buffer_load_dwordx4 v3, s[64:67], s59 offen offset:1024 lds
  buffer_load_dwordx4 v3, s[64:67], s59 offen offset:2048 lds
  buffer_load_dwordx4 v3, s[64:67], s59 offen offset:3072 lds
  s_add_u32 m0, s53, 8192
  s_add_u32 s59, s57, 8192
  buffer_load_dwordx4 v3, s[64:67], s59 offen offset:0 lds
  buffer_load_dwordx4 v3, s[64:67], s59 offen offset:1024 lds
  buffer_load_dwordx4 v3, s[64:67], s59 offen offset:2048 lds
  buffer_load_dwordx4 v3, s[64:67], s59 offen offset:3072 lds
  s_add_u32 m0, s53, 12288
  s_add_u32 s59, s57, 12288
  buffer_load_dwordx4 v3, s[64:67], s59 offen offset:0 lds
  buffer_load_dwordx4 v3, s[64:67], s59 offen offset:1024 lds
  buffer_load_dwordx4 v3, s[64:67], s59 offen offset:2048 lds
  buffer_load_dwordx4 v3, s[64:67], s59 offen offset:3072 lds
  v_add_f32 v72, v72, v88
  v_add_f32 v104, v104, v120
  v_add_f32 v73, v73, v89
  v_add_f32 v105, v105, v121
  v_add_f32 v74, v74, v90
  v_add_f32 v106, v106, v122
  v_add_f32 v75, v75, v91
  v_add_f32 v107, v107, v123
  v_add_f32 v76, v76, v92
  v_add_f32 v108, v108, v124
  v_add_f32 v77, v77, v93
  v_add_f32 v109, v109, v125
  v_add_f32 v78, v78, v94
  v_add_f32 v110, v110, v126
  v_add_f32 v79, v79, v95
  v_add_f32 v111, v111, v127
  v_add_f32 v80, v80, v96
  v_add_f32 v112, v112, v128
  v_add_f32 v81, v81, v97
  v_add_f32 v113, v113, v129
  v_add_f32 v82, v82, v98
  v_add_f32 v114, v114, v130
  v_add_f32 v83, v83, v99
  v_add_f32 v115, v115, v131
  v_add_f32 v84, v84, v100
  v_add_f32 v116, v116, v132
  v_add_f32 v85, v85, v101
  v_add_f32 v117, v117, v133
  v_add_f32 v86, v86, v102
  v_add_f32 v118, v118, v134
  v_add_f32 v87, v87, v103
  v_add_f32 v119, v119, v135
  v_add_f32 v72, v72, v104
  v_add_f32 v73, v73, v105
  v_add_f32 v74, v74, v106
  v_add_f32 v75, v75, v107
  v_add_f32 v76, v76, v108
  v_add_f32 v77, v77, v109
  v_add_f32 v78, v78, v110
  v_add_f32 v79, v79, v111
  v_add_f32 v80, v80, v112
  v_add_f32 v81, v81, v113
  v_add_f32 v82, v82, v114
  v_add_f32 v83, v83, v115
  v_add_f32 v84, v84, v116
  v_add_f32 v85, v85, v117
  v_add_f32 v86, v86, v118
  v_add_f32 v87, v87, v119
  v_mul_f32 v88, s48, v72
  v_mul_f32 v89, s48, v73
  v_mul_f32 v90, s48, v74
  v_mul_f32 v91, s48, v75
  v_mul_f32 v92, s48, v76
  v_mul_f32 v93, s48, v77
  v_mul_f32 v94, s48, v78
  v_mul_f32 v95, s48, v79
  v_mul_f32 v96, s48, v80
  v_mul_f32 v97, s48, v81
  v_mul_f32 v98, s48, v82
  v_mul_f32 v99, s48, v83
  v_mul_f32 v100, s48, v84
  v_mul_f32 v101, s48, v85
  v_mul_f32 v102, s48, v86
  v_mul_f32 v103, s48, v87
  v_exp_f32 v88, v88
  v_exp_f32 v89, v89
  v_exp_f32 v90, v90
  v_exp_f32 v91, v91
  v_exp_f32 v92, v92
  v_exp_f32 v93, v93
  v_exp_f32 v94, v94
  v_exp_f32 v95, v95
  v_exp_f32 v96, v96
  v_exp_f32 v97, v97
  v_exp_f32 v98, v98
  v_exp_f32 v99, v99
  v_exp_f32 v100, v100
  v_exp_f32 v101, v101
  v_exp_f32 v102, v102
  v_exp_f32 v103, v103
  v_add_u32 v4, s51, v3
  v_add_u32 v5, s52, v3
  v_add_u32 v5, 0x10000, v5
  s_waitcnt vmcnt(32)
  v_permlane32_swap_b32 v152, v154
  v_permlane32_swap_b32 v153, v155
  v_permlane32_swap_b32 v156, v158
  v_permlane32_swap_b32 v157, v159
  v_add_f32 v88, 1.0, v88
  v_add_f32 v89, 1.0, v89
  v_add_f32 v90, 1.0, v90
  v_add_f32 v91, 1.0, v91
  v_add_f32 v92, 1.0, v92
  v_add_f32 v93, 1.0, v93
  v_add_f32 v94, 1.0, v94
  v_add_f32 v95, 1.0, v95
  v_add_f32 v96, 1.0, v96
  v_add_f32 v97, 1.0, v97
  v_add_f32 v98, 1.0, v98
  v_add_f32 v99, 1.0, v99
  v_add_f32 v100, 1.0, v100
  v_add_f32 v101, 1.0, v101
  v_add_f32 v102, 1.0, v102
  v_add_f32 v103, 1.0, v103
  v_rcp_f32 v88, v88
  v_rcp_f32 v89, v89
  v_rcp_f32 v90, v90
  v_rcp_f32 v91, v91
  v_rcp_f32 v92, v92
  v_rcp_f32 v93, v93
  v_rcp_f32 v94, v94
  v_rcp_f32 v95, v95
  v_rcp_f32 v96, v96
  v_rcp_f32 v97, v97
  v_rcp_f32 v98, v98
  v_rcp_f32 v99, v99
  v_rcp_f32 v100, v100
  v_rcp_f32 v101, v101
  v_rcp_f32 v102, v102
  v_rcp_f32 v103, v103
  v_lshlrev_b32 v104, 16, v152
  v_and_b32 v105, 0xffff0000, v152
  v_lshlrev_b32 v106, 16, v153
  v_and_b32 v107, 0xffff0000, v153
  v_lshlrev_b32 v108, 16, v154
  v_and_b32 v109, 0xffff0000, v154
  v_lshlrev_b32 v110, 16, v155
  v_and_b32 v111, 0xffff0000, v155
  v_lshlrev_b32 v112, 16, v156
  v_and_b32 v113, 0xffff0000, v156
  v_lshlrev_b32 v114, 16, v157
  v_and_b32 v115, 0xffff0000, v157
  v_lshlrev_b32 v116, 16, v158
  v_and_b32 v117, 0xffff0000, v158
  v_lshlrev_b32 v118, 16, v159
  v_and_b32 v119, 0xffff0000, v159
  v_mul_f32 v72, v72, v88
  v_mul_f32 v73, v73, v89
  v_mul_f32 v74, v74, v90
  v_mul_f32 v75, v75, v91
  v_mul_f32 v76, v76, v92
  v_mul_f32 v77, v77, v93
  v_mul_f32 v78, v78, v94
  v_mul_f32 v79, v79, v95
  v_mul_f32 v80, v80, v96
  v_mul_f32 v81, v81, v97
  v_mul_f32 v82, v82, v98
  v_mul_f32 v83, v83, v99
  v_mul_f32 v84, v84, v100
  v_mul_f32 v85, v85, v101
  v_mul_f32 v86, v86, v102
  v_mul_f32 v87, v87, v103
  v_mov_b32 v8, 0
  v_mov_b32 v9, 0
  v_mov_b32 v10, 0
  v_mov_b32 v11, 0
  v_mov_b32 v12, 0
  v_mov_b32 v13, 0
  v_mov_b32 v14, 0
  v_mov_b32 v15, 0
  v_mov_b32 v16, 0
  v_mov_b32 v17, 0
  v_mov_b32 v18, 0
  v_mov_b32 v19, 0
  v_mov_b32 v20, 0
  v_mov_b32 v21, 0
  v_mov_b32 v22, 0
  v_mov_b32 v23, 0
  s_waitcnt vmcnt(0)
  s_barrier
  ds_read_b128 v[24:27], v5 offset:0
  ds_read_b128 v[28:31], v4 offset:0
  ds_read_b128 v[32:35], v5 offset:1024
  ds_read_b128 v[36:39], v4 offset:1024
  ds_read_b128 v[40:43], v5 offset:2048
  ds_read_b128 v[44:47], v4 offset:2048
  ds_read_b128 v[48:51], v5 offset:3072
  ds_read_b128 v[52:55], v4 offset:3072
  s_waitcnt lgkmcnt(6)
  v_mfma_f32_32x32x16_bf16 v[8:23], v[24:27], v[28:31], v[8:23]
  ds_read_b128 v[24:27], v5 offset:4096
  ds_read_b128 v[28:31], v4 offset:4096
  s_waitcnt lgkmcnt(6)
  v_mfma_f32_32x32x16_bf16 v[8:23], v[32:35], v[36:39], v[8:23]
  ds_read_b128 v[32:35], v5 offset:5120
  ds_read_b128 v[36:39], v4 offset:5120
  s_waitcnt lgkmcnt(6)
  v_mfma_f32_32x32x16_bf16 v[8:23], v[40:43], v[44:47], v[8:23]
  ds_read_b128 v[40:43], v5 offset:6144
  ds_read_b128 v[44:47], v4 offset:6144
  s_waitcnt lgkmcnt(6)
  v_mfma_f32_32x32x16_bf16 v[8:23], v[48:51], v[52:55], v[8:23]
  ds_read_b128 v[48:51], v5 offset:7168
  ds_read_b128 v[52:55], v4 offset:7168
  s_waitcnt lgkmcnt(6)
  v_mfma_f32_32x32x16_bf16 v[8:23], v[24:27], v[28:31], v[8:23]
  ds_read_b128 v[24:27], v5 offset:8192
  ds_read_b128 v[28:31], v4 offset:8192
  s_waitcnt lgkmcnt(6)
  v_mfma_f32_32x32x16_bf16 v[8:23], v[32:35], v[36:39], v[8:23]
  ds_read_b128 v[32:35], v5 offset:9216
  ds_read_b128 v[36:39], v4 offset:9216
  s_waitcnt lgkmcnt(6)
  v_mfma_f32_32x32x16_bf16 v[8:23], v[40:43], v[44:47], v[8:23]
  ds_read_b128 v[40:43], v5 offset:10240
  ds_read_b128 v[44:47], v4 offset:10240
  s_waitcnt lgkmcnt(6)
  v_mfma_f32_32x32x16_bf16 v[8:23], v[48:51], v[52:55], v[8:23]
  ds_read_b128 v[48:51], v5 offset:11264
  ds_read_b128 v[52:55], v4 offset:11264
  s_waitcnt lgkmcnt(6)
  v_mfma_f32_32x32x16_bf16 v[8:23], v[24:27], v[28:31], v[8:23]
  ds_read_b128 v[24:27], v5 offset:12288
  ds_read_b128 v[28:31], v4 offset:12288
  s_waitcnt lgkmcnt(6)
  v_mfma_f32_32x32x16_bf16 v[8:23], v[32:35], v[36:39], v[8:23]
  ds_read_b128 v[32:35], v5 offset:13312
  ds_read_b128 v[36:39], v4 offset:13312
  s_waitcnt lgkmcnt(6)
  v_mfma_f32_32x32x16_bf16 v[8:23], v[40:43], v[44:47], v[8:23]
  ds_read_b128 v[40:43], v5 offset:14336
  ds_read_b128 v[44:47], v4 offset:14336
  s_waitcnt lgkmcnt(6)
  v_mfma_f32_32x32x16_bf16 v[8:23], v[48:51], v[52:55], v[8:23]
  ds_read_b128 v[48:51], v5 offset:15360
  ds_read_b128 v[52:55], v4 offset:15360
  s_waitcnt lgkmcnt(6)
  v_mfma_f32_32x32x16_bf16 v[8:23], v[24:27], v[28:31], v[8:23]
  ds_read_b128 v[24:27], v5 offset:16384
  ds_read_b128 v[28:31], v4 offset:16384
  s_waitcnt lgkmcnt(6)
  v_mfma_f32_32x32x16_bf16 v[8:23], v[32:35], v[36:39], v[8:23]
  ds_read_b128 v[32:35], v5 offset:17408
  ds_read_b128 v[36:39], v4 offset:17408
  s_waitcnt lgkmcnt(6)
  v_mfma_f32_32x32x16_bf16 v[8:23], v[40:43], v[44:47], v[8:23]
  ds_read_b128 v[40:43], v5 offset:18432
  ds_read_b128 v[44:47], v4 offset:18432
  s_waitcnt lgkmcnt(6)
  v_mfma_f32_32x32x16_bf16 v[8:23], v[48:51], v[52:55], v[8:23]
  ds_read_b128 v[48:51], v5 offset:19456
  ds_read_b128 v[52:55], v4 offset:19456
  s_waitcnt lgkmcnt(6)
  v_mfma_f32_32x32x16_bf16 v[8:23], v[24:27], v[28:31], v[8:23]
  ds_read_b128 v[24:27], v5 offset:20480
  ds_read_b128 v[28:31], v4 offset:20480
  s_waitcnt lgkmcnt(6)
  v_mfma_f32_32x32x16_bf16 v[8:23], v[32:35], v[36:39], v[8:23]
  ds_read_b128 v[32:35], v5 offset:21504
  ds_read_b128 v[36:39], v4 offset:21504
  s_waitcnt lgkmcnt(6)
  v_mfma_f32_32x32x16_bf16 v[8:23], v[40:43], v[44:47], v[8:23]
  ds_read_b128 v[40:43], v5 offset:22528
  ds_read_b128 v[44:47], v4 offset:22528
  s_waitcnt lgkmcnt(6)
  v_mfma_f32_32x32x16_bf16 v[8:23], v[48:51], v[52:55], v[8:23]
  ds_read_b128 v[48:51], v5 offset:23552
  ds_read_b128 v[52:55], v4 offset:23552
  s_waitcnt lgkmcnt(6)
  v_mfma_f32_32x32x16_bf16 v[8:23], v[24:27], v[28:31], v[8:23]
  ds_read_b128 v[24:27], v5 offset:24576
  ds_read_b128 v[28:31], v4 offset:24576
  s_waitcnt lgkmcnt(6)
  v_mfma_f32_32x32x16_bf16 v[8:23], v[32:35], v[36:39], v[8:23]
  ds_read_b128 v[32:35], v5 offset:25600
  ds_read_b128 v[36:39], v4 offset:25600
  s_waitcnt lgkmcnt(6)
  v_mfma_f32_32x32x16_bf16 v[8:23], v[40:43], v[44:47], v[8:23]
  ds_read_b128 v[40:43], v5 offset:26624
  ds_read_b128 v[44:47], v4 offset:26624
  s_waitcnt lgkmcnt(6)
  v_mfma_f32_32x32x16_bf16 v[8:23], v[48:51], v[52:55], v[8:23]
  ds_read_b128 v[48:51], v5 offset:27648
  ds_read_b128 v[52:55], v4 offset:27648
  s_waitcnt lgkmcnt(6)
  v_mfma_f32_32x32x16_bf16 v[8:23], v[24:27], v[28:31], v[8:23]
  ds_read_b128 v[24:27], v5 offset:28672
  ds_read_b128 v[28:31], v4 offset:28672
  s_waitcnt lgkmcnt(6)
  v_mfma_f32_32x32x16_bf16 v[8:23], v[32:35], v[36:39], v[8:23]
  ds_read_b128 v[32:35], v5 offset:29696
  ds_read_b128 v[36:39], v4 offset:29696
  s_waitcnt lgkmcnt(6)
  v_mfma_f32_32x32x16_bf16 v[8:23], v[40:43], v[44:47], v[8:23]
  ds_read_b128 v[40:43], v5 offset:30720
  ds_read_b128 v[44:47], v4 offset:30720
  s_waitcnt lgkmcnt(6)
  v_mfma_f32_32x32x16_bf16 v[8:23], v[48:51], v[52:55], v[8:23]
  ds_read_b128 v[48:51], v5 offset:31744
  ds_read_b128 v[52:55], v4 offset:31744
  s_waitcnt lgkmcnt(6)
  v_mfma_f32_32x32x16_bf16 v[8:23], v[24:27], v[28:31], v[8:23]
  s_waitcnt lgkmcnt(4)
  v_mfma_f32_32x32x16_bf16 v[8:23], v[32:35], v[36:39], v[8:23]
  s_waitcnt lgkmcnt(2)
  v_mfma_f32_32x32x16_bf16 v[8:23], v[40:43], v[44:47], v[8:23]
  s_waitcnt lgkmcnt(0)
  v_mfma_f32_32x32x16_bf16 v[8:23], v[48:51], v[52:55], v[8:23]
  s_nop 11
  v_fma_f32 v8, v8, v72, v104
  v_fma_f32 v9, v9, v73, v105
  v_fma_f32 v10, v10, v74, v106
  v_fma_f32 v11, v11, v75, v107
  v_fma_f32 v12, v12, v76, v108
  v_fma_f32 v13, v13, v77, v109
  v_fma_f32 v14, v14, v78, v110
  v_fma_f32 v15, v15, v79, v111
  v_fma_f32 v16, v16, v80, v112
  v_fma_f32 v17, v17, v81, v113
  v_fma_f32 v18, v18, v82, v114
  v_fma_f32 v19, v19, v83, v115
  v_fma_f32 v20, v20, v84, v116
  v_fma_f32 v21, v21, v85, v117
  v_fma_f32 v22, v22, v86, v118
  v_fma_f32 v23, v23, v87, v119
  v_cvt_pk_bf16_f32 v8, v8, v9
  v_cvt_pk_bf16_f32 v9, v10, v11
  v_cvt_pk_bf16_f32 v10, v12, v13
  v_cvt_pk_bf16_f32 v11, v14, v15
  v_cvt_pk_bf16_f32 v12, v16, v17
  v_cvt_pk_bf16_f32 v13, v18, v19
  v_cvt_pk_bf16_f32 v14, v20, v21
  v_cvt_pk_bf16_f32 v15, v22, v23
  s_nop 1
  v_permlane32_swap_b32 v8, v10
  v_permlane32_swap_b32 v9, v11
  v_permlane32_swap_b32 v12, v14
  v_permlane32_swap_b32 v13, v15
  s_nop 1
  buffer_store_dwordx4 v[8:11], v2, s[32:35], s50 offen
  buffer_store_dwordx4 v[12:15], v2, s[32:35], s50 offen offset:32
  s_endpgm
k2_kernel_end:
  s_endpgm
.section .rodata,"a"
.p2align 6
.amdhsa_kernel k1_kernel
  .amdhsa_next_free_vgpr 168
  .amdhsa_next_free_sgpr 100
  .amdhsa_accum_offset 168
  .amdhsa_group_segment_fixed_size 0
  .amdhsa_kernarg_size 80
  .amdhsa_user_sgpr_count 2
  .amdhsa_user_sgpr_kernarg_segment_ptr 1
  .amdhsa_system_sgpr_workgroup_id_x 1
.end_amdhsa_kernel
.section .rodata,"a"
.p2align 6
.amdhsa_kernel k2_kernel
  .amdhsa_next_free_vgpr 168
  .amdhsa_next_free_sgpr 100
  .amdhsa_accum_offset 168
  .amdhsa_group_segment_fixed_size 0
  .amdhsa_kernarg_size 80
  .amdhsa_user_sgpr_count 2
  .amdhsa_user_sgpr_kernarg_segment_ptr 1
  .amdhsa_system_sgpr_workgroup_id_x 1
.end_amdhsa_kernel
```
